```python
import torch

def _softmax(x, axis=-1):
    return torch.softmax(x, dim=axis)

def _gelu(x):
    return torch.nn.functional.gelu(x, approximate='tanh')

def _silu(x):
    return torch.nn.functional.silu(x)

def _sigmoid(x):
    return torch.sigmoid(x)

def _layernorm(x, axis=-1, eps=1e-05):
    m = x.mean(dim=axis, keepdim=True)
    v = x.var(dim=axis, keepdim=True, unbiased=False)
    return (x - m) / torch.sqrt(v + eps)

def _scatter_add(tgt, idx, src, axis=0):
    return tgt.clone().index_add_(axis, idx, src)

def _segment_sum(src, seg, n):
    out = torch.zeros((n,) + src.shape[1:], dtype=src.dtype)
    return out.index_add_(0, seg, src)

def _pad(x, pw):
    flat = tuple((v for pair in reversed(pw) for v in pair))
    return torch.nn.functional.pad(x, flat)
kernel_name = 'adaLN_cond__ssm_conv_h3__glu_gated_geglu__prompt'

def setup_inputs():

    _w = lambda a: (lambda t: t.to(torch.bfloat16) if t.is_floating_point() else t)(torch.as_tensor(a))

    def _A_setup():
        B, S, D = (1, 2048, 1024)
        ks = 4
        return {'q': _w((lambda *s: torch.randn(*s, dtype=torch.bfloat16) * 0.05)(B, S, D)), 'k': _w((lambda *s: torch.randn(*s, dtype=torch.bfloat16) * 1.6)(B, S, D)), 'v': _w((lambda *s: torch.randn(*s, dtype=torch.bfloat16) * 1.6)(B, S, D)), 'shift_k': _w((lambda *s: torch.randn(*s, dtype=torch.bfloat16) * 1.6)(D, ks) * 0.5), 'ssm_k': _w((lambda *s: torch.randn(*s, dtype=torch.bfloat16) * 1.6)(D, S) * (1.0 / S ** 0.5)), 'ssm_D': _w((lambda *s: torch.randn(*s, dtype=torch.bfloat16) * 1.6)(D))}
    _A_in = _A_setup()

    def _B_setup():
        B, S, Dm, Df = (1, 2048, 1024, 3584)
        return {'x': _w((lambda *s: torch.randn(*s, dtype=torch.bfloat16) * 0.05)(B, S, Dm)), 'w_gate': _w((lambda *s: torch.randn(*s, dtype=torch.bfloat16) * 3.2)(Dm, Df) * Dm ** (-0.5)), 'w_up': _w((lambda *s: torch.randn(*s, dtype=torch.bfloat16) * 3.2)(Dm, Df) * Dm ** (-0.5)), 'w_down': _w((lambda *s: torch.randn(*s, dtype=torch.bfloat16) * 3.2)(Df, Dm) * Df ** (-0.5))}
    _B_in = _B_setup()
    return {'A_q': _A_in['q'], 'A_k': _A_in['k'], 'A_v': _A_in['v'], 'A_shift_k': _A_in['shift_k'], 'A_ssm_k': _A_in['ssm_k'], 'A_ssm_D': _A_in['ssm_D'], 'B_x': _B_in['x'], 'B_w_gate': _B_in['w_gate'], 'B_w_up': _B_in['w_up'], 'B_w_down': _B_in['w_down'], 'c': _w((lambda *s: torch.randn(*s, dtype=torch.bfloat16) * 0.1)(1, 1024) * 8.0), 'w_mod': _w((lambda *s: torch.randn(*s, dtype=torch.bfloat16) * 0.1)(1024, 6 * 1024) * 1024 ** (-0.5) * 8.0)}

def reference(A_q, A_k, A_v, A_shift_k, A_ssm_k, A_ssm_D, B_x, B_w_gate, B_w_up, B_w_down, c, w_mod):

    def _A_ref(q, k, v, shift_k, ssm_k, ssm_D):
        B, S, D = q.shape
        ks = shift_k.shape[-1]
        k_pad = _pad(k, ((0, 0), (ks - 1, 0), (0, 0)))
        k_shift = torch.zeros_like(k)
        for t in range(ks):
            k_shift = k_shift + k_pad[:, t:t + S, :] * shift_k[:, ks - 1 - t][None, None, :]
        kv = k_shift * v
        L = 2 * S
        kv_pad = _pad(kv, ((0, 0), (0, S), (0, 0)))
        kf_pad = _pad(ssm_k, ((0, 0), (0, S)))
        kv_f = (lambda x, axes=(-2, -1): torch.fft.rfft2(x.float(), dim=axes))(kv_pad[:, None, :, :], axes=(1, 2))
        kf_f = (lambda x, axes=(-2, -1): torch.fft.rfft2(x.float(), dim=axes))(kf_pad[:, None, :], axes=(1, 2))
        kf_f = (lambda x, *d: x.permute(*d))(kf_f, 1, 2, 0)
        y_f = kv_f * kf_f[None, :, :, :]
        y = (lambda x, s, axes=(-2, -1): torch.fft.irfft2(x, s=s, dim=axes).to(torch.bfloat16))(y_f, (1, L), axes=(1, 2))[:, 0, :S, :]
        y = y + kv * ssm_D[None, None, :]
        return q * y

    def _B_ref(x, w_gate, w_up, w_down):
        g = torch.einsum('bsd,df->bsf', x, w_gate)
        u = torch.einsum('bsd,df->bsf', x, w_up)
        h = _gelu(g) * u
        return torch.einsum('bsf,fd->bsd', h, w_down)
    x = A_q
    mod = (_silu(c) @ w_mod).reshape(c.shape[0], 6, 1, -1)
    sa, ca, ga, sb, cb, gb = (mod[:, 0].clone(), mod[:, 1].clone(), mod[:, 2].clone(), mod[:, 3].clone(), mod[:, 4].clone(), mod[:, 5].clone())
    h = _layernorm(x, axis=-1) * (1 + ca) + sa
    x = x + ga * _A_ref(h, A_k, A_v, A_shift_k, A_ssm_k, A_ssm_D)
    h = _layernorm(x, axis=-1) * (1 + cb) + sb
    x = x + gb * _B_ref(h, B_w_gate, B_w_up, B_w_down)
    return x
```

```asm
; @launch kernel=front_kernel grid=(256,1,1) block=(512,1,1) lds=135168
; @launch kernel=ffn2_kernel grid=(256,1,1) block=(512,1,1) lds=65536
.amdgcn_target "amdgcn-amd-amdhsa--gfx950"
.text
.globl front_kernel
.p2align 8
.type front_kernel,@function
front_kernel:
    s_cmp_ge_u32 s2, 256
    s_cbranch_scc1 FE_END
    s_load_dwordx4 s[4:7], s[0:1], 8
    s_load_dwordx4 s[52:55], s[0:1], 24
    s_load_dwordx2 s[56:57], s[0:1], 40
    s_load_dwordx4 s[44:47], s[0:1], 80
    s_load_dwordx4 s[48:51], s[0:1], 104
    s_load_dwordx2 s[58:59], s[0:1], 0
    s_memrealtime s[64:65]
    v_lshrrev_b32 v1, 6, v0
    s_mov_b32 s63, 0xffff0000
    v_readfirstlane_b32 s62, v1
    s_lshr_b32 s40, s2, 4
    s_and_b32 s41, s2, 15
    v_lshrrev_b32 v1, 3, v0
    v_and_b32 v2, 7, v0
    s_lshl_b32 s42, s40, 7
    v_lshl_add_u32 v3, v1, 1, s42
    v_lshlrev_b32 v4, 11, v3
    v_lshl_add_u32 v4, v2, 4, v4
    s_lshl_b32 s43, s41, 7
    v_add_u32 v4, s43, v4
    v_bfrev_b32 v8, 1
    v_subrev_u32 v5, 6144, v4
    v_cmp_gt_u32 vcc, 3, v3
    s_nop 1
    v_cndmask_b32 v5, v5, v8, vcc
    v_subrev_u32 v6, 4096, v4
    v_cmp_gt_u32 vcc, 2, v3
    s_nop 1
    v_cndmask_b32 v6, v6, v8, vcc
    v_subrev_u32 v7, 2048, v4
    v_cmp_gt_u32 vcc, 1, v3
    s_nop 1
    v_cndmask_b32 v7, v7, v8, vcc
    v_lshlrev_b32 v9, 6, v2
    s_lshl_b32 s60, s41, 9
    s_and_b32 s3, s2, 7
    s_lshl_b32 s3, s3, 5
    s_lshr_b32 s61, s2, 3
    s_add_u32 s3, s3, s61
    v_lshlrev_b32 v92, 2, v0
    v_and_b32 v61, 255, v0
    s_lshl_b32 s66, s3, 14
    v_lshlrev_b32 v62, 4, v61
    v_add_u32 v62, s66, v62
    v_subrev_u32 v63, 4, v62
    v_cmp_eq_u32 vcc, 0, v61
    s_nop 1
    v_cndmask_b32 v63, v63, v62, vcc
    s_waitcnt lgkmcnt(0)
    s_mov_b32 s8, s4
    s_mov_b32 s9, s5
    s_mov_b32 s10, 4194304
    s_mov_b32 s11, 0x00020000
    s_mov_b32 s12, s6
    s_mov_b32 s13, s7
    s_mov_b32 s14, 4194304
    s_mov_b32 s15, 0x00020000
    s_mov_b32 s20, s52
    s_mov_b32 s21, s53
    s_mov_b32 s22, 8192
    s_mov_b32 s23, 0x00020000
    s_mov_b32 s72, s44
    s_mov_b32 s73, s45
    s_mov_b32 s74, 2048
    s_mov_b32 s75, 0x00020000
    buffer_load_dword v128, v92, s[72:75], 0 offen
    buffer_load_dwordx4 v[16:19], v5, s[8:11], 0 offen
    buffer_load_dwordx4 v[20:23], v6, s[8:11], 0 offen
    buffer_load_dwordx4 v[24:27], v7, s[8:11], 0 offen
    buffer_load_dwordx4 v[28:31], v4, s[8:11], 0 offen
    buffer_load_dwordx4 v[32:35], v4, s[8:11], 0 offen offset:2048
    buffer_load_dwordx4 v[36:39], v4, s[12:15], 0 offen
    buffer_load_dwordx4 v[40:43], v4, s[12:15], 0 offen offset:2048
    buffer_load_dwordx4 v[44:47], v9, s[20:23], s60 offen offset:0
    buffer_load_dwordx4 v[48:51], v9, s[20:23], s60 offen offset:16
    buffer_load_dwordx4 v[52:55], v9, s[20:23], s60 offen offset:32
    buffer_load_dwordx4 v[56:59], v9, s[20:23], s60 offen offset:48
    s_mov_b32 s16, s54
    s_mov_b32 s17, s55
    s_mov_b32 s18, 4194304
    s_mov_b32 s19, 0x00020000
    s_mov_b32 s24, s48
    s_mov_b32 s25, s49
    s_mov_b32 s26, 256
    s_mov_b32 s27, 0x00020000
    s_mov_b32 s28, s50
    s_mov_b32 s29, s51
    s_mov_b32 s30, 1048576
    s_mov_b32 s31, 0x00020000
    s_or_b32 s64, s64, 1
    s_cmp_lg_u32 s2, 0
    s_cbranch_scc1 FE_NONONCE
    v_mov_b32 v10, s64
    v_mov_b32 v11, s65
    v_mov_b32 v12, 0
    s_cmp_lg_u32 s62, 0
    s_cbranch_scc1 FE_NOTW0
    s_mov_b64 exec, 1
    buffer_store_dwordx2 v[10:11], v12, s[24:27], 0 offen sc1
    s_mov_b64 exec, -1
FE_NOTW0:
FE_NONONCE:
    s_lshl_b32 s68, s3, 3
    s_load_dwordx2 s[70:71], s[56:57], s68
    s_mov_b32 s32, s58
    s_mov_b32 s33, s59
    s_mov_b32 s34, 4194304
    s_mov_b32 s35, 0x00020000
    v_and_b32 v90, 63, v0
    v_lshlrev_b32 v91, 4, v90
    v_mov_b32 v146, v91
    s_lshl_b32 s69, s2, 3
    s_add_u32 s69, s69, s62
    s_lshl_b32 s69, s69, 11
    s_mov_b32 s78, 0x05040100
    s_mov_b32 s79, 0x07060302
    v_sub_u32 v10, 63, v1
    v_lshlrev_b32 v11, 3, v2
    v_xor_b32 v10, v10, v11
    v_lshlrev_b32 v10, 2, v10
    v_lshl_add_u32 v10, v2, 11, v10
    v_add_u32 v10, 51712, v10
    v_mov_b32 v133, 80384
    v_mov_b32 v136, 0
    v_mov_b32 v137, 0
    v_mov_b32 v138, 0
    v_mov_b32 v139, 0
    ds_write_b128 v133, v[136:139]
    ds_write_b128 v133, v[136:139] offset:16
    ds_write_b128 v133, v[136:139] offset:32
    s_waitcnt vmcnt(11)
    v_lshlrev_b32 v130, 16, v128
    v_and_b32 v131, s63, v128
    v_mul_f32 v132, 0xbfb8aa3b, v130
    v_exp_f32 v132, v132
    s_nop 0
    v_add_f32 v132, 1.0, v132
    v_rcp_f32 v132, v132
    s_nop 0
    v_mul_f32 v130, v130, v132
    v_mul_f32 v132, 0xbfb8aa3b, v131
    v_exp_f32 v132, v132
    s_nop 0
    v_add_f32 v132, 1.0, v132
    v_rcp_f32 v132, v132
    s_nop 0
    v_mul_f32 v131, v131, v132
    v_cvt_pk_bf16_f32 v130, v130, v131
    v_add_u32 v133, 70144, v92
    ds_write_b32 v133, v130
    s_waitcnt vmcnt(0)
    v_perm_b32 v64, v24, v28, s78
    v_perm_b32 v65, v16, v20, s78
    v_perm_b32 v66, v28, v32, s78
    v_perm_b32 v67, v20, v24, s78
    v_dot2_f32_bf16 v68, v64, v44, 0
    v_dot2_f32_bf16 v69, v66, v44, 0
    v_dot2c_f32_bf16 v68, v65, v45
    v_dot2c_f32_bf16 v69, v67, v45
    v_lshlrev_b32 v70, 16, v36
    v_lshlrev_b32 v71, 16, v40
    v_mul_f32 v68, v68, v70
    v_mul_f32 v69, v69, v71
    v_cvt_pk_bf16_f32 v64, v69, v68
    ds_write_b32 v10, v64 offset:0
    v_perm_b32 v72, v24, v28, s79
    v_perm_b32 v73, v16, v20, s79
    v_perm_b32 v74, v28, v32, s79
    v_perm_b32 v75, v20, v24, s79
    v_dot2_f32_bf16 v76, v72, v46, 0
    v_dot2_f32_bf16 v77, v74, v46, 0
    v_dot2c_f32_bf16 v76, v73, v47
    v_dot2c_f32_bf16 v77, v75, v47
    v_and_b32 v78, s63, v36
    v_and_b32 v79, s63, v40
    v_mul_f32 v76, v76, v78
    v_mul_f32 v77, v77, v79
    v_cvt_pk_bf16_f32 v72, v77, v76
    ds_write_b32 v10, v72 offset:256
    v_perm_b32 v64, v25, v29, s78
    v_perm_b32 v65, v17, v21, s78
    v_perm_b32 v66, v29, v33, s78
    v_perm_b32 v67, v21, v25, s78
    v_dot2_f32_bf16 v68, v64, v48, 0
    v_dot2_f32_bf16 v69, v66, v48, 0
    v_dot2c_f32_bf16 v68, v65, v49
    v_dot2c_f32_bf16 v69, v67, v49
    v_lshlrev_b32 v70, 16, v37
    v_lshlrev_b32 v71, 16, v41
    v_mul_f32 v68, v68, v70
    v_mul_f32 v69, v69, v71
    v_cvt_pk_bf16_f32 v64, v69, v68
    ds_write_b32 v10, v64 offset:512
    v_perm_b32 v72, v25, v29, s79
    v_perm_b32 v73, v17, v21, s79
    v_perm_b32 v74, v29, v33, s79
    v_perm_b32 v75, v21, v25, s79
    v_dot2_f32_bf16 v76, v72, v50, 0
    v_dot2_f32_bf16 v77, v74, v50, 0
    v_dot2c_f32_bf16 v76, v73, v51
    v_dot2c_f32_bf16 v77, v75, v51
    v_and_b32 v78, s63, v37
    v_and_b32 v79, s63, v41
    v_mul_f32 v76, v76, v78
    v_mul_f32 v77, v77, v79
    v_cvt_pk_bf16_f32 v72, v77, v76
    ds_write_b32 v10, v72 offset:768
    v_perm_b32 v64, v26, v30, s78
    v_perm_b32 v65, v18, v22, s78
    v_perm_b32 v66, v30, v34, s78
    v_perm_b32 v67, v22, v26, s78
    v_dot2_f32_bf16 v68, v64, v52, 0
    v_dot2_f32_bf16 v69, v66, v52, 0
    v_dot2c_f32_bf16 v68, v65, v53
    v_dot2c_f32_bf16 v69, v67, v53
    v_lshlrev_b32 v70, 16, v38
    v_lshlrev_b32 v71, 16, v42
    v_mul_f32 v68, v68, v70
    v_mul_f32 v69, v69, v71
    v_cvt_pk_bf16_f32 v64, v69, v68
    ds_write_b32 v10, v64 offset:1024
    v_perm_b32 v72, v26, v30, s79
    v_perm_b32 v73, v18, v22, s79
    v_perm_b32 v74, v30, v34, s79
    v_perm_b32 v75, v22, v26, s79
    v_dot2_f32_bf16 v76, v72, v54, 0
    v_dot2_f32_bf16 v77, v74, v54, 0
    v_dot2c_f32_bf16 v76, v73, v55
    v_dot2c_f32_bf16 v77, v75, v55
    v_and_b32 v78, s63, v38
    v_and_b32 v79, s63, v42
    v_mul_f32 v76, v76, v78
    v_mul_f32 v77, v77, v79
    v_cvt_pk_bf16_f32 v72, v77, v76
    ds_write_b32 v10, v72 offset:1280
    v_perm_b32 v64, v27, v31, s78
    v_perm_b32 v65, v19, v23, s78
    v_perm_b32 v66, v31, v35, s78
    v_perm_b32 v67, v23, v27, s78
    v_dot2_f32_bf16 v68, v64, v56, 0
    v_dot2_f32_bf16 v69, v66, v56, 0
    v_dot2c_f32_bf16 v68, v65, v57
    v_dot2c_f32_bf16 v69, v67, v57
    v_lshlrev_b32 v70, 16, v39
    v_lshlrev_b32 v71, 16, v43
    v_mul_f32 v68, v68, v70
    v_mul_f32 v69, v69, v71
    v_cvt_pk_bf16_f32 v64, v69, v68
    ds_write_b32 v10, v64 offset:1536
    v_perm_b32 v72, v27, v31, s79
    v_perm_b32 v73, v19, v23, s79
    v_perm_b32 v74, v31, v35, s79
    v_perm_b32 v75, v23, v27, s79
    v_dot2_f32_bf16 v76, v72, v58, 0
    v_dot2_f32_bf16 v77, v74, v58, 0
    v_dot2c_f32_bf16 v76, v73, v59
    v_dot2c_f32_bf16 v77, v75, v59
    v_and_b32 v78, s63, v39
    v_and_b32 v79, s63, v43
    v_mul_f32 v76, v76, v78
    v_mul_f32 v77, v77, v79
    v_cvt_pk_bf16_f32 v72, v77, v76
    ds_write_b32 v10, v72 offset:1792
    v_bfe_u32 v1, v0, 4, 4
    v_and_b32 v2, 15, v0
    v_lshlrev_b32 v3, 4, v2
    v_lshrrev_b32 v4, 3, v1
    v_lshlrev_b32 v4, 5, v4
    v_xor_b32 v4, v4, v3
    v_lshl_add_u32 v4, v1, 8, v4
    v_mul_u32_u24 v6, 4224, v1
    v_add_u32 v6, v6, v3
    s_mul_i32 s80, s41, 270336
    s_lshl_b32 s81, s40, 8
    s_sub_u32 s80, s80, s81
    s_add_u32 s80, s80, 3840
    s_add_u32 s8, s50, 14680064
    s_addc_u32 s9, s51, 0
    s_mov_b32 s10, 4325376
    s_mov_b32 s11, 0x00020000
    s_add_u32 s12, s50, 1048576
    s_addc_u32 s13, s51, 0
    s_mov_b32 s14, 4227072
    s_mov_b32 s15, 0x00020000
    s_waitcnt lgkmcnt(0)
    s_barrier
    s_cmp_ge_u32 s62, 4
    s_cbranch_scc1 FE_GB
    v_xor_b32 v5, 0, v4
    ds_read_b128 v[16:19], v5 offset:51712
    v_xor_b32 v5, 64, v4
    ds_read_b128 v[20:23], v5 offset:55808
    v_xor_b32 v5, 128, v4
    ds_read_b128 v[24:27], v5 offset:59904
    v_xor_b32 v5, 192, v4
    ds_read_b128 v[28:31], v5 offset:64000
    s_waitcnt lgkmcnt(3)
    buffer_store_dwordx4 v[16:19], v6, s[8:11], s80 offen sc1
    s_add_u32 s80, s80, 67584
    s_waitcnt lgkmcnt(2)
    buffer_store_dwordx4 v[20:23], v6, s[8:11], s80 offen sc1
    s_add_u32 s80, s80, 67584
    s_waitcnt lgkmcnt(1)
    buffer_store_dwordx4 v[24:27], v6, s[8:11], s80 offen sc1
    s_add_u32 s80, s80, 67584
    s_waitcnt lgkmcnt(0)
    buffer_store_dwordx4 v[28:31], v6, s[8:11], s80 offen sc1
    s_cmp_lg_u32 s62, 0
    s_cbranch_scc1 FE_NONP
    v_mov_b32 v12, 0
    s_mov_b32 s90, 65536
FE_PN:
    buffer_load_dwordx2 v[156:157], v12, s[24:27], 0 offen sc1
    s_waitcnt vmcnt(0)
    v_cmp_ne_u32 vcc, 0, v156
    s_nop 1
    s_cmp_eq_u64 vcc, -1
    s_cbranch_scc1 FE_PN_OK
    s_sleep 0
    s_sub_u32 s90, s90, 1
    s_cmp_lg_u32 s90, 0
    s_cbranch_scc1 FE_PN
FE_PN_OK:
FE_NONP:
    s_waitcnt vmcnt(0)
    s_waitcnt lgkmcnt(0)
    v_mov_b32 v12, 80404
    v_mov_b32 v13, 1
    s_mov_b64 exec, 1
    ds_add_u32 v12, v13
    s_mov_b64 exec, -1
    s_cmp_lg_u32 s62, 0
    s_cbranch_scc1 FE_S0_SKIP
    v_mov_b32 v12, 80404
    s_mov_b32 s90, 1048576
FE_WU:
    ds_read_b32 v13, v12
    s_waitcnt lgkmcnt(0)
    v_cmp_eq_u32 vcc, 4, v13
    s_nop 1
    s_cmp_eq_u64 vcc, -1
    s_cbranch_scc1 FE_WU_OK
    s_sub_u32 s90, s90, 1
    s_cmp_lg_u32 s90, 0
    s_cbranch_scc1 FE_WU
FE_WU_OK:
    v_mov_b32 v12, 0
    s_lshl_b32 s82, s41, 7
    s_lshl_b32 s83, s40, 3
    s_add_u32 s82, s82, s83
    s_add_u32 s82, s82, 65536
    s_mov_b64 exec, 1
    buffer_store_dwordx2 v[156:157], v12, s[28:31], s82 offen sc1
    s_mov_b64 exec, -1
    s_lshr_b32 s84, s3, 4
    v_and_b32 v12, 15, v0
    v_lshlrev_b32 v12, 3, v12
    s_lshl_b32 s85, s84, 7
    s_add_u32 s85, s85, 65536
    s_mov_b32 s90, 65536
FE_P0:
    buffer_load_dwordx2 v[10:11], v12, s[28:31], s85 offen sc1
    s_waitcnt vmcnt(0)
    v_cmp_eq_u64 vcc, v[10:11], v[156:157]
    s_nop 1
    s_cmp_eq_u64 vcc, -1
    s_cbranch_scc1 FE_P0_OK
    s_sleep 0
    s_sub_u32 s90, s90, 1
    s_cmp_lg_u32 s90, 0
    s_cbranch_scc1 FE_P0
FE_P0_OK:
    s_waitcnt lgkmcnt(0)
    v_mov_b32 v12, 80408
    v_mov_b32 v13, 1
    s_mov_b64 exec, 1
    ds_add_u32 v12, v13
    s_mov_b64 exec, -1
FE_S0_SKIP:
    v_mov_b32 v12, 80408
    s_mov_b32 s90, 1048576
FE_WS:
    ds_read_b32 v13, v12
    s_waitcnt lgkmcnt(0)
    v_cmp_eq_u32 vcc, 1, v13
    s_nop 1
    s_cmp_eq_u64 vcc, -1
    s_cbranch_scc1 FE_WS_OK
    s_sub_u32 s90, s90, 1
    s_cmp_lg_u32 s90, 0
    s_cbranch_scc1 FE_WS
FE_WS_OK:
    v_lshlrev_b32 v13, 4, v0
    s_mul_i32 s66, s3, 16896
    buffer_load_dwordx4 v[16:19], v13, s[8:11], s66 offen sc1
    s_add_u32 s66, s66, 4224
    buffer_load_dwordx4 v[20:23], v13, s[8:11], s66 offen sc1
    s_add_u32 s66, s66, 4224
    buffer_load_dwordx4 v[24:27], v13, s[8:11], s66 offen sc1
    s_add_u32 s66, s66, 4224
    buffer_load_dwordx4 v[28:31], v13, s[8:11], s66 offen sc1
    s_add_u32 s66, s66, 4224
    s_waitcnt lgkmcnt(0)
    v_mov_b32 v12, 80416
    v_mov_b32 v14, 1
    s_mov_b64 exec, 1
    ds_add_u32 v12, v14
    s_mov_b64 exec, -1
    v_and_b32 v1, 15, v0
    v_bfe_u32 v2, v0, 4, 2
    s_mul_i32 s88, s62, 4608
    s_add_u32 s88, s88, 528
    v_lshlrev_b32 v3, 5, v1
    v_lshl_add_u32 v3, v2, 4, v3
    v_sub_u32 v120, s88, v3
    s_mul_i32 s88, s62, 8320
    s_add_u32 s88, s88, 18482
    v_lshlrev_b32 v3, 1, v1
    v_lshlrev_b32 v4, 4, v2
    v_sub_u32 v3, v3, v4
    v_add_u32 v3, s88, v3
    v_add_u32 v4, 4162, v3
    v_and_b32 v5, 1, v1
    v_cmp_eq_u32 vcc, 1, v5
    s_nop 1
    v_cndmask_b32 v121, v4, v3, vcc
    v_add_u32 v122, 1024, v121
    v_add_u32 v123, 2048, v121
    v_add_u32 v124, 3072, v121
    v_mov_b32 v88, 0
    v_mov_b32 v89, 0
    v_mov_b32 v90, 0
    v_mov_b32 v91, 0
    v_mov_b32 v92, 0
    v_mov_b32 v93, 0
    v_mov_b32 v94, 0
    v_mov_b32 v95, 0
    v_mov_b32 v96, 0
    v_mov_b32 v97, 0
    v_mov_b32 v98, 0
    v_mov_b32 v99, 0
    v_mov_b32 v100, 0
    v_mov_b32 v101, 0
    v_mov_b32 v102, 0
    v_mov_b32 v103, 0
    v_mov_b32 v104, 0
    v_mov_b32 v105, 0
    v_mov_b32 v106, 0
    v_mov_b32 v107, 0
    v_mov_b32 v108, 0
    v_mov_b32 v109, 0
    v_mov_b32 v110, 0
    v_mov_b32 v111, 0
    v_mov_b32 v112, 0
    v_mov_b32 v113, 0
    v_mov_b32 v114, 0
    v_mov_b32 v115, 0
    v_mov_b32 v116, 0
    v_mov_b32 v117, 0
    v_mov_b32 v118, 0
    v_mov_b32 v119, 0
    s_lshr_b32 s88, s62, 1
    s_cmp_eq_u32 s88, 0
    s_cselect_b32 s88, s70, s71
    s_bitcmp1_b32 s62, 0
    s_cselect_b32 s89, 0, 16
    s_lshl_b32 s88, s88, s89
    s_and_b32 s91, s88, s63
    s_waitcnt vmcnt(3)
    ds_write_b128 v13, v[16:19] offset:0
    s_waitcnt vmcnt(2)
    ds_write_b128 v13, v[20:23] offset:4608
    s_waitcnt vmcnt(1)
    ds_write_b128 v13, v[24:27] offset:9216
    s_waitcnt vmcnt(0)
    ds_write_b128 v13, v[28:31] offset:13824
    s_waitcnt lgkmcnt(0)
    v_mov_b32 v12, 80392
    v_mov_b32 v14, 1
    s_mov_b64 exec, 1
    ds_add_u32 v12, v14
    s_mov_b64 exec, -1
    v_mov_b32 v12, 80400
    s_mov_b32 s90, 1048576
FE_WF:
    ds_read_b32 v14, v12
    s_waitcnt lgkmcnt(0)
    v_cmp_eq_u32 vcc, 4, v14
    s_nop 1
    s_cmp_eq_u64 vcc, -1
    s_cbranch_scc1 FE_WF_OK
    s_sub_u32 s90, s90, 1
    s_cmp_lg_u32 s90, 0
    s_cbranch_scc1 FE_WF
FE_WF_OK:
    v_mov_b32 v12, 80392
    s_mov_b32 s90, 1048576
FE_WA1:
    ds_read_b32 v14, v12
    s_waitcnt lgkmcnt(0)
    v_cmp_eq_u32 vcc, 4, v14
    s_nop 1
    s_cmp_eq_u64 vcc, -1
    s_cbranch_scc1 FE_WA1_OK
    s_sub_u32 s90, s90, 1
    s_cmp_lg_u32 s90, 0
    s_cbranch_scc1 FE_WA1
FE_WA1_OK:
    ds_read2_b32 v[24:25], v121 offset0:0 offset1:1
    ds_read2_b32 v[26:27], v121 offset0:2 offset1:3
    ds_read_b128 v[56:59], v120 offset:3584
    ds_read_b128 v[60:63], v120 offset:3072
    ds_read_b128 v[64:67], v120 offset:2560
    ds_read_b128 v[68:71], v120 offset:2048
    ds_read_b128 v[72:75], v120 offset:1536
    ds_read_b128 v[76:79], v120 offset:1024
    ds_read_b128 v[80:83], v120 offset:512
    ds_read_b128 v[84:87], v120 offset:0
    ds_read2_b32 v[28:29], v121 offset0:128 offset1:129
    ds_read2_b32 v[30:31], v121 offset0:130 offset1:131
    ds_read2_b32 v[32:33], v122 offset0:0 offset1:1
    s_waitcnt lgkmcnt(8)
    ds_read2_b32 v[34:35], v122 offset0:2 offset1:3
    ds_read2_b32 v[36:37], v122 offset0:128 offset1:129
    ds_read2_b32 v[38:39], v122 offset0:130 offset1:131
    ds_read2_b32 v[40:41], v123 offset0:0 offset1:1
    ds_read2_b32 v[42:43], v123 offset0:2 offset1:3
    s_waitcnt lgkmcnt(8)
    ds_read2_b32 v[44:45], v123 offset0:128 offset1:129
    ds_read2_b32 v[46:47], v123 offset0:130 offset1:131
    ds_read2_b32 v[48:49], v124 offset0:0 offset1:1
    ds_read2_b32 v[50:51], v124 offset0:2 offset1:3
    ds_read2_b32 v[52:53], v124 offset0:128 offset1:129
    s_waitcnt lgkmcnt(8)
    ds_read2_b32 v[54:55], v124 offset0:130 offset1:131
    s_waitcnt lgkmcnt(0)
    s_mov_b32 s92, 4
FE_RHO:
    v_mfma_f32_16x16x32_bf16 v[88:91], v[24:27], v[56:59], v[88:91]
    ds_read2_b32 v[160:161], v121 offset0:16 offset1:17
    v_mfma_f32_16x16x32_bf16 v[92:95], v[24:27], v[60:63], v[92:95]
    ds_read2_b32 v[162:163], v121 offset0:18 offset1:19
    v_mfma_f32_16x16x32_bf16 v[96:99], v[24:27], v[64:67], v[96:99]
    ds_read_b128 v[192:195], v120 offset:3648
    v_mfma_f32_16x16x32_bf16 v[100:103], v[24:27], v[68:71], v[100:103]
    ds_read_b128 v[196:199], v120 offset:3136
    v_mfma_f32_16x16x32_bf16 v[104:107], v[24:27], v[72:75], v[104:107]
    ds_read_b128 v[200:203], v120 offset:2624
    v_mfma_f32_16x16x32_bf16 v[108:111], v[24:27], v[76:79], v[108:111]
    ds_read_b128 v[204:207], v120 offset:2112
    v_mfma_f32_16x16x32_bf16 v[112:115], v[24:27], v[80:83], v[112:115]
    ds_read_b128 v[208:211], v120 offset:1600
    v_mfma_f32_16x16x32_bf16 v[116:119], v[24:27], v[84:87], v[116:119]
    ds_read_b128 v[212:215], v120 offset:1088
    v_mfma_f32_16x16x32_bf16 v[92:95], v[28:31], v[56:59], v[92:95]
    ds_read_b128 v[216:219], v120 offset:576
    v_mfma_f32_16x16x32_bf16 v[96:99], v[28:31], v[60:63], v[96:99]
    ds_read_b128 v[220:223], v120 offset:64
    v_mfma_f32_16x16x32_bf16 v[100:103], v[28:31], v[64:67], v[100:103]
    ds_read2_b32 v[164:165], v121 offset0:144 offset1:145
    v_mfma_f32_16x16x32_bf16 v[104:107], v[28:31], v[68:71], v[104:107]
    ds_read2_b32 v[166:167], v121 offset0:146 offset1:147
    v_mfma_f32_16x16x32_bf16 v[108:111], v[28:31], v[72:75], v[108:111]
    ds_read2_b32 v[168:169], v122 offset0:16 offset1:17
    s_waitcnt lgkmcnt(8)
    v_mfma_f32_16x16x32_bf16 v[112:115], v[28:31], v[76:79], v[112:115]
    ds_read2_b32 v[170:171], v122 offset0:18 offset1:19
    v_mfma_f32_16x16x32_bf16 v[116:119], v[28:31], v[80:83], v[116:119]
    ds_read2_b32 v[172:173], v122 offset0:144 offset1:145
    v_mfma_f32_16x16x32_bf16 v[96:99], v[32:35], v[56:59], v[96:99]
    ds_read2_b32 v[174:175], v122 offset0:146 offset1:147
    v_mfma_f32_16x16x32_bf16 v[100:103], v[32:35], v[60:63], v[100:103]
    ds_read2_b32 v[176:177], v123 offset0:16 offset1:17
    v_mfma_f32_16x16x32_bf16 v[104:107], v[32:35], v[64:67], v[104:107]
    ds_read2_b32 v[178:179], v123 offset0:18 offset1:19
    s_waitcnt lgkmcnt(8)
    v_mfma_f32_16x16x32_bf16 v[108:111], v[32:35], v[68:71], v[108:111]
    ds_read2_b32 v[180:181], v123 offset0:144 offset1:145
    v_mfma_f32_16x16x32_bf16 v[112:115], v[32:35], v[72:75], v[112:115]
    ds_read2_b32 v[182:183], v123 offset0:146 offset1:147
    v_mfma_f32_16x16x32_bf16 v[116:119], v[32:35], v[76:79], v[116:119]
    ds_read2_b32 v[184:185], v124 offset0:16 offset1:17
    v_mfma_f32_16x16x32_bf16 v[100:103], v[36:39], v[56:59], v[100:103]
    ds_read2_b32 v[186:187], v124 offset0:18 offset1:19
    v_mfma_f32_16x16x32_bf16 v[104:107], v[36:39], v[60:63], v[104:107]
    ds_read2_b32 v[188:189], v124 offset0:144 offset1:145
    s_waitcnt lgkmcnt(8)
    v_mfma_f32_16x16x32_bf16 v[108:111], v[36:39], v[64:67], v[108:111]
    ds_read2_b32 v[190:191], v124 offset0:146 offset1:147
    v_mfma_f32_16x16x32_bf16 v[112:115], v[36:39], v[68:71], v[112:115]
    v_mfma_f32_16x16x32_bf16 v[116:119], v[36:39], v[72:75], v[116:119]
    v_mfma_f32_16x16x32_bf16 v[104:107], v[40:43], v[56:59], v[104:107]
    v_mfma_f32_16x16x32_bf16 v[108:111], v[40:43], v[60:63], v[108:111]
    v_mfma_f32_16x16x32_bf16 v[112:115], v[40:43], v[64:67], v[112:115]
    v_mfma_f32_16x16x32_bf16 v[116:119], v[40:43], v[68:71], v[116:119]
    v_mfma_f32_16x16x32_bf16 v[108:111], v[44:47], v[56:59], v[108:111]
    v_mfma_f32_16x16x32_bf16 v[112:115], v[44:47], v[60:63], v[112:115]
    v_mfma_f32_16x16x32_bf16 v[116:119], v[44:47], v[64:67], v[116:119]
    v_mfma_f32_16x16x32_bf16 v[112:115], v[48:51], v[56:59], v[112:115]
    v_mfma_f32_16x16x32_bf16 v[116:119], v[48:51], v[60:63], v[116:119]
    v_mfma_f32_16x16x32_bf16 v[116:119], v[52:55], v[56:59], v[116:119]
    s_waitcnt lgkmcnt(0)
    v_mfma_f32_16x16x32_bf16 v[88:91], v[160:163], v[192:195], v[88:91]
    ds_read2_b32 v[24:25], v121 offset0:32 offset1:33
    v_mfma_f32_16x16x32_bf16 v[92:95], v[160:163], v[196:199], v[92:95]
    ds_read2_b32 v[26:27], v121 offset0:34 offset1:35
    v_mfma_f32_16x16x32_bf16 v[96:99], v[160:163], v[200:203], v[96:99]
    ds_read_b128 v[56:59], v120 offset:3712
    v_mfma_f32_16x16x32_bf16 v[100:103], v[160:163], v[204:207], v[100:103]
    ds_read_b128 v[60:63], v120 offset:3200
    v_mfma_f32_16x16x32_bf16 v[104:107], v[160:163], v[208:211], v[104:107]
    ds_read_b128 v[64:67], v120 offset:2688
    v_mfma_f32_16x16x32_bf16 v[108:111], v[160:163], v[212:215], v[108:111]
    ds_read_b128 v[68:71], v120 offset:2176
    v_mfma_f32_16x16x32_bf16 v[112:115], v[160:163], v[216:219], v[112:115]
    ds_read_b128 v[72:75], v120 offset:1664
    v_mfma_f32_16x16x32_bf16 v[116:119], v[160:163], v[220:223], v[116:119]
    ds_read_b128 v[76:79], v120 offset:1152
    v_mfma_f32_16x16x32_bf16 v[92:95], v[164:167], v[192:195], v[92:95]
    ds_read_b128 v[80:83], v120 offset:640
    v_mfma_f32_16x16x32_bf16 v[96:99], v[164:167], v[196:199], v[96:99]
    ds_read_b128 v[84:87], v120 offset:128
    v_mfma_f32_16x16x32_bf16 v[100:103], v[164:167], v[200:203], v[100:103]
    ds_read2_b32 v[28:29], v121 offset0:160 offset1:161
    v_mfma_f32_16x16x32_bf16 v[104:107], v[164:167], v[204:207], v[104:107]
    ds_read2_b32 v[30:31], v121 offset0:162 offset1:163
    v_mfma_f32_16x16x32_bf16 v[108:111], v[164:167], v[208:211], v[108:111]
    ds_read2_b32 v[32:33], v122 offset0:32 offset1:33
    s_waitcnt lgkmcnt(8)
    v_mfma_f32_16x16x32_bf16 v[112:115], v[164:167], v[212:215], v[112:115]
    ds_read2_b32 v[34:35], v122 offset0:34 offset1:35
    v_mfma_f32_16x16x32_bf16 v[116:119], v[164:167], v[216:219], v[116:119]
    ds_read2_b32 v[36:37], v122 offset0:160 offset1:161
    v_mfma_f32_16x16x32_bf16 v[96:99], v[168:171], v[192:195], v[96:99]
    ds_read2_b32 v[38:39], v122 offset0:162 offset1:163
    v_mfma_f32_16x16x32_bf16 v[100:103], v[168:171], v[196:199], v[100:103]
    ds_read2_b32 v[40:41], v123 offset0:32 offset1:33
    v_mfma_f32_16x16x32_bf16 v[104:107], v[168:171], v[200:203], v[104:107]
    ds_read2_b32 v[42:43], v123 offset0:34 offset1:35
    s_waitcnt lgkmcnt(8)
    v_mfma_f32_16x16x32_bf16 v[108:111], v[168:171], v[204:207], v[108:111]
    ds_read2_b32 v[44:45], v123 offset0:160 offset1:161
    v_mfma_f32_16x16x32_bf16 v[112:115], v[168:171], v[208:211], v[112:115]
    ds_read2_b32 v[46:47], v123 offset0:162 offset1:163
    v_mfma_f32_16x16x32_bf16 v[116:119], v[168:171], v[212:215], v[116:119]
    ds_read2_b32 v[48:49], v124 offset0:32 offset1:33
    v_mfma_f32_16x16x32_bf16 v[100:103], v[172:175], v[192:195], v[100:103]
    ds_read2_b32 v[50:51], v124 offset0:34 offset1:35
    v_mfma_f32_16x16x32_bf16 v[104:107], v[172:175], v[196:199], v[104:107]
    ds_read2_b32 v[52:53], v124 offset0:160 offset1:161
    s_waitcnt lgkmcnt(8)
    v_mfma_f32_16x16x32_bf16 v[108:111], v[172:175], v[200:203], v[108:111]
    ds_read2_b32 v[54:55], v124 offset0:162 offset1:163
    v_mfma_f32_16x16x32_bf16 v[112:115], v[172:175], v[204:207], v[112:115]
    v_mfma_f32_16x16x32_bf16 v[116:119], v[172:175], v[208:211], v[116:119]
    v_mfma_f32_16x16x32_bf16 v[104:107], v[176:179], v[192:195], v[104:107]
    v_mfma_f32_16x16x32_bf16 v[108:111], v[176:179], v[196:199], v[108:111]
    v_mfma_f32_16x16x32_bf16 v[112:115], v[176:179], v[200:203], v[112:115]
    v_mfma_f32_16x16x32_bf16 v[116:119], v[176:179], v[204:207], v[116:119]
    v_mfma_f32_16x16x32_bf16 v[108:111], v[180:183], v[192:195], v[108:111]
    v_mfma_f32_16x16x32_bf16 v[112:115], v[180:183], v[196:199], v[112:115]
    v_mfma_f32_16x16x32_bf16 v[116:119], v[180:183], v[200:203], v[116:119]
    v_mfma_f32_16x16x32_bf16 v[112:115], v[184:187], v[192:195], v[112:115]
    v_mfma_f32_16x16x32_bf16 v[116:119], v[184:187], v[196:199], v[116:119]
    v_mfma_f32_16x16x32_bf16 v[116:119], v[188:191], v[192:195], v[116:119]
    s_waitcnt lgkmcnt(0)
    v_add_u32 v121, 128, v121
    v_add_u32 v122, 128, v122
    v_add_u32 v123, 128, v123
    v_add_u32 v124, 128, v124
    v_add_u32 v120, 128, v120
    s_sub_u32 s92, s92, 1
    s_cmp_lg_u32 s92, 0
    s_cbranch_scc1 FE_RHO
    s_mul_i32 s88, s62, 4608
    s_add_u32 s88, s88, 504
    v_lshlrev_b32 v3, 5, v1
    v_lshl_add_u32 v3, v2, 3, v3
    v_sub_u32 v3, s88, v3
    ds_read_b64 v[24:25], v3 offset:3584
    ds_read_b64 v[26:27], v3 offset:3072
    ds_read_b64 v[28:29], v3 offset:2560
    ds_read_b64 v[30:31], v3 offset:2048
    ds_read_b64 v[32:33], v3 offset:1536
    ds_read_b64 v[34:35], v3 offset:1024
    ds_read_b64 v[36:37], v3 offset:512
    ds_read_b64 v[38:39], v3 offset:0
    s_lshl_b32 s89, s62, 4
    s_add_u32 s88, s89, 51712
    v_mul_u32_u24 v4, 144, v1
    v_lshrrev_b32 v6, 1, v2
    v_lshl_add_u32 v4, v6, 6, v4
    v_and_b32 v6, 1, v2
    v_lshl_add_u32 v4, v6, 3, v4
    v_add_u32 v4, s88, v4
    s_waitcnt lgkmcnt(0)
    v_lshlrev_b32 v51, 16, v24
    v_and_b32 v50, s63, v24
    v_lshlrev_b32 v49, 16, v25
    v_and_b32 v48, s63, v25
    v_fma_f32 v88, s91, v48, v88
    v_fma_f32 v89, s91, v49, v89
    v_fma_f32 v90, s91, v50, v90
    v_fma_f32 v91, s91, v51, v91
    v_cvt_pk_bf16_f32 v52, v88, v89
    v_cvt_pk_bf16_f32 v53, v90, v91
    ds_write_b64 v4, v[52:53] offset:0
    v_lshlrev_b32 v59, 16, v26
    v_and_b32 v58, s63, v26
    v_lshlrev_b32 v57, 16, v27
    v_and_b32 v56, s63, v27
    v_fma_f32 v92, s91, v56, v92
    v_fma_f32 v93, s91, v57, v93
    v_fma_f32 v94, s91, v58, v94
    v_fma_f32 v95, s91, v59, v95
    v_cvt_pk_bf16_f32 v60, v92, v93
    v_cvt_pk_bf16_f32 v61, v94, v95
    ds_write_b64 v4, v[60:61] offset:2304
    v_lshlrev_b32 v51, 16, v28
    v_and_b32 v50, s63, v28
    v_lshlrev_b32 v49, 16, v29
    v_and_b32 v48, s63, v29
    v_fma_f32 v96, s91, v48, v96
    v_fma_f32 v97, s91, v49, v97
    v_fma_f32 v98, s91, v50, v98
    v_fma_f32 v99, s91, v51, v99
    v_cvt_pk_bf16_f32 v52, v96, v97
    v_cvt_pk_bf16_f32 v53, v98, v99
    ds_write_b64 v4, v[52:53] offset:4608
    v_lshlrev_b32 v59, 16, v30
    v_and_b32 v58, s63, v30
    v_lshlrev_b32 v57, 16, v31
    v_and_b32 v56, s63, v31
    v_fma_f32 v100, s91, v56, v100
    v_fma_f32 v101, s91, v57, v101
    v_fma_f32 v102, s91, v58, v102
    v_fma_f32 v103, s91, v59, v103
    v_cvt_pk_bf16_f32 v60, v100, v101
    v_cvt_pk_bf16_f32 v61, v102, v103
    ds_write_b64 v4, v[60:61] offset:6912
    v_lshlrev_b32 v51, 16, v32
    v_and_b32 v50, s63, v32
    v_lshlrev_b32 v49, 16, v33
    v_and_b32 v48, s63, v33
    v_fma_f32 v104, s91, v48, v104
    v_fma_f32 v105, s91, v49, v105
    v_fma_f32 v106, s91, v50, v106
    v_fma_f32 v107, s91, v51, v107
    v_cvt_pk_bf16_f32 v52, v104, v105
    v_cvt_pk_bf16_f32 v53, v106, v107
    ds_write_b64 v4, v[52:53] offset:9216
    v_lshlrev_b32 v59, 16, v34
    v_and_b32 v58, s63, v34
    v_lshlrev_b32 v57, 16, v35
    v_and_b32 v56, s63, v35
    v_fma_f32 v108, s91, v56, v108
    v_fma_f32 v109, s91, v57, v109
    v_fma_f32 v110, s91, v58, v110
    v_fma_f32 v111, s91, v59, v111
    v_cvt_pk_bf16_f32 v60, v108, v109
    v_cvt_pk_bf16_f32 v61, v110, v111
    ds_write_b64 v4, v[60:61] offset:11520
    v_lshlrev_b32 v51, 16, v36
    v_and_b32 v50, s63, v36
    v_lshlrev_b32 v49, 16, v37
    v_and_b32 v48, s63, v37
    v_fma_f32 v112, s91, v48, v112
    v_fma_f32 v113, s91, v49, v113
    v_fma_f32 v114, s91, v50, v114
    v_fma_f32 v115, s91, v51, v115
    v_cvt_pk_bf16_f32 v52, v112, v113
    v_cvt_pk_bf16_f32 v53, v114, v115
    ds_write_b64 v4, v[52:53] offset:13824
    v_lshlrev_b32 v59, 16, v38
    v_and_b32 v58, s63, v38
    v_lshlrev_b32 v57, 16, v39
    v_and_b32 v56, s63, v39
    v_fma_f32 v116, s91, v56, v116
    v_fma_f32 v117, s91, v57, v117
    v_fma_f32 v118, s91, v58, v118
    v_fma_f32 v119, s91, v59, v119
    v_cvt_pk_bf16_f32 v60, v116, v117
    v_cvt_pk_bf16_f32 v61, v118, v119
    ds_write_b64 v4, v[60:61] offset:16128
    v_bfe_u32 v3, v0, 2, 6
    v_and_b32 v4, 3, v0
    v_lshrrev_b32 v5, 1, v3
    v_mul_u32_u24 v5, 144, v5
    v_and_b32 v6, 1, v3
    v_lshl_add_u32 v5, v6, 6, v5
    v_lshl_add_u32 v5, v4, 4, v5
    v_add_u32 v5, 51712, v5
    v_mul_u32_u24 v6, 16512, v3
    v_lshl_add_u32 v6, v4, 4, v6
    s_lshl_b32 s88, s3, 6
    s_waitcnt lgkmcnt(0)
    v_mov_b32 v12, 80396
    v_mov_b32 v13, 1
    s_mov_b64 exec, 1
    ds_add_u32 v12, v13
    s_mov_b64 exec, -1
    v_mov_b32 v12, 80396
    s_mov_b32 s90, 1048576
FE_WA2:
    ds_read_b32 v13, v12
    s_waitcnt lgkmcnt(0)
    v_cmp_eq_u32 vcc, 4, v13
    s_nop 1
    s_cmp_eq_u64 vcc, -1
    s_cbranch_scc1 FE_WA2_OK
    s_sub_u32 s90, s90, 1
    s_cmp_lg_u32 s90, 0
    s_cbranch_scc1 FE_WA2
FE_WA2_OK:
    ds_read_b128 v[8:11], v5 offset:0
    ds_read_b128 v[12:15], v5 offset:4608
    ds_read_b128 v[16:19], v5 offset:9216
    ds_read_b128 v[20:23], v5 offset:13824
    s_waitcnt lgkmcnt(3)
    buffer_store_dwordx4 v[8:11], v6, s[12:15], s88 offen sc1
    s_add_u32 s88, s88, 1056768
    s_waitcnt lgkmcnt(2)
    buffer_store_dwordx4 v[12:15], v6, s[12:15], s88 offen sc1
    s_add_u32 s88, s88, 1056768
    s_waitcnt lgkmcnt(1)
    buffer_store_dwordx4 v[16:19], v6, s[12:15], s88 offen sc1
    s_add_u32 s88, s88, 1056768
    s_waitcnt lgkmcnt(0)
    buffer_store_dwordx4 v[20:23], v6, s[12:15], s88 offen sc1
    s_branch FE_YJ
FE_GB:
    v_mov_b32 v133, 80404
    s_mov_b32 s90, 1048576
FE_WU2:
    ds_read_b32 v134, v133
    s_waitcnt lgkmcnt(0)
    v_cmp_eq_u32 vcc, 4, v134
    s_nop 1
    s_cmp_eq_u64 vcc, -1
    s_cbranch_scc1 FE_WU2_OK
    s_sub_u32 s90, s90, 1
    s_cmp_lg_u32 s90, 0
    s_cbranch_scc1 FE_WU2
FE_WU2_OK:
    s_mov_b32 s67, 0
    buffer_load_dwordx4 v[96:99], v62, s[16:19], s67 offen
    buffer_load_dword v112, v63, s[16:19], s67 offen
    s_add_u32 s67, s67, 4096
    buffer_load_dwordx4 v[100:103], v62, s[16:19], s67 offen
    buffer_load_dword v113, v63, s[16:19], s67 offen
    s_add_u32 s67, s67, 4096
    buffer_load_dwordx4 v[104:107], v62, s[16:19], s67 offen
    buffer_load_dword v114, v63, s[16:19], s67 offen
    s_add_u32 s67, s67, 4096
    buffer_load_dwordx4 v[108:111], v62, s[16:19], s67 offen
    buffer_load_dword v115, v63, s[16:19], s67 offen
    s_waitcnt vmcnt(0)
    v_lshlrev_b32 v48, 4, v61
    v_add_u32 v48, 18464, v48
    v_cmp_eq_u32 vcc, 0, v61
    s_nop 1
    v_cndmask_b32 v112, v112, 0, vcc
    v_cndmask_b32 v113, v113, 0, vcc
    v_cndmask_b32 v114, v114, 0, vcc
    v_cndmask_b32 v115, v115, 0, vcc
    ds_write_b128 v48, v[96:99] offset:0
    v_alignbit_b32 v116, v96, v112, 16
    v_alignbit_b32 v117, v97, v96, 16
    v_alignbit_b32 v118, v98, v97, 16
    v_alignbit_b32 v119, v99, v98, 16
    ds_write_b128 v48, v[116:119] offset:4160
    ds_write_b128 v48, v[100:103] offset:8320
    v_alignbit_b32 v120, v100, v113, 16
    v_alignbit_b32 v121, v101, v100, 16
    v_alignbit_b32 v122, v102, v101, 16
    v_alignbit_b32 v123, v103, v102, 16
    ds_write_b128 v48, v[120:123] offset:12480
    ds_write_b128 v48, v[104:107] offset:16640
    v_alignbit_b32 v116, v104, v114, 16
    v_alignbit_b32 v117, v105, v104, 16
    v_alignbit_b32 v118, v106, v105, 16
    v_alignbit_b32 v119, v107, v106, 16
    ds_write_b128 v48, v[116:119] offset:20800
    ds_write_b128 v48, v[108:111] offset:24960
    v_alignbit_b32 v120, v108, v115, 16
    v_alignbit_b32 v121, v109, v108, 16
    v_alignbit_b32 v122, v110, v109, 16
    v_alignbit_b32 v123, v111, v110, 16
    ds_write_b128 v48, v[120:123] offset:29120
    v_mov_b32 v136, 0
    v_mov_b32 v137, 0
    v_mov_b32 v138, 0
    v_mov_b32 v139, 0
    v_bfe_u32 v140, v0, 5, 2
    v_mul_u32_u24 v140, 4608, v140
    v_and_b32 v141, 31, v0
    v_lshl_add_u32 v140, v141, 4, v140
    v_add_u32 v140, 4096, v140
    v_and_b32 v141, 7, v0
    v_bfe_u32 v142, v0, 3, 2
    v_mul_u32_u24 v142, 8320, v142
    v_subrev_u32 v143, 2, v141
    v_min_u32 v143, 3, v143
    v_lshlrev_b32 v143, 4, v143
    v_add_u32 v143, 4128, v143
    v_lshlrev_b32 v144, 4, v141
    v_cmp_gt_u32 vcc, 2, v141
    s_nop 1
    v_cndmask_b32 v143, v143, v144, vcc
    v_add_u32 v142, v142, v143
    v_add_u32 v142, 18432, v142
    v_and_b32 v141, 128, v0
    v_cmp_eq_u32 vcc, 0, v141
    s_nop 1
    v_cndmask_b32 v140, v142, v140, vcc
    ds_write_b128 v140, v[136:139]
    s_waitcnt lgkmcnt(0)
    v_mov_b32 v133, 80400
    v_mov_b32 v134, 1
    s_mov_b64 exec, 1
    ds_add_u32 v133, v134
    s_mov_b64 exec, -1
    s_mov_b32 s36, s46
    s_mov_b32 s37, s47
    s_mov_b32 s38, 12582912
    s_mov_b32 s39, 0x00020000
    s_cmp_lt_u32 s2, 192
    s_cselect_b32 s38, 12582912, 0
    s_mul_i32 s76, s2, 1366
    s_lshr_b32 s76, s76, 16
    s_mul_i32 s77, s76, 48
    s_sub_u32 s42, s2, s77
    s_sub_u32 s65, s62, 4
    s_lshl_b32 s76, s76, 8
    s_lshl_b32 s77, s65, 6
    s_add_u32 s76, s76, s77
    s_lshl_b32 s64, s76, 1
    s_mul_i32 s77, s76, 12288
    s_lshl_b32 s76, s42, 8
    s_add_u32 s77, s77, s76
    s_add_u32 s64, s64, 70144
    v_lshrrev_b32 v135, 4, v90
    v_lshlrev_b32 v133, 2, v135
    v_add_u32 v133, s64, v133
    ds_read_b32 v136, v133 offset:0
    ds_read_b32 v137, v133 offset:16
    ds_read_b32 v138, v133 offset:32
    ds_read_b32 v139, v133 offset:48
    ds_read_b32 v140, v133 offset:64
    ds_read_b32 v141, v133 offset:80
    ds_read_b32 v142, v133 offset:96
    ds_read_b32 v143, v133 offset:112
    s_mov_b32 s76, 24576
    v_mul_lo_u32 v93, s76, v135
    v_and_b32 v95, 15, v90
    v_lshl_add_u32 v93, v95, 4, v93
    v_mov_b32 v160, 0
    v_mov_b32 v161, 0
    v_mov_b32 v162, 0
    v_mov_b32 v163, 0
    v_mov_b32 v164, 0
    v_mov_b32 v165, 0
    v_mov_b32 v166, 0
    v_mov_b32 v167, 0
    s_cmp_lg_u32 s62, 7
    s_cbranch_scc1 FE_NON7
    v_mov_b32 v133, 0
    s_mov_b32 s90, 65536
FE_PN7:
    buffer_load_dword v156, v133, s[24:27], 0 offen offset:8 sc1
    s_waitcnt vmcnt(0)
    v_cmp_ne_u32 vcc, 0, v156
    s_nop 1
    s_cmp_eq_u64 vcc, -1
    s_cbranch_scc1 FE_PN7_OK
    s_sleep 0
    s_sub_u32 s90, s90, 1
    s_cmp_lg_u32 s90, 0
    s_cbranch_scc1 FE_PN7
FE_PN7_OK:
    s_waitcnt lgkmcnt(0)
    v_mov_b32 v133, 80412
    v_mov_b32 v134, 1
    s_mov_b64 exec, 1
    ds_add_u32 v133, v134
    s_mov_b64 exec, -1
FE_NON7:
    v_mov_b32 v133, 80416
    s_mov_b32 s90, 1048576
FE_WL:
    ds_read_b32 v134, v133
    s_waitcnt lgkmcnt(0)
    v_cmp_eq_u32 vcc, 4, v134
    s_nop 1
    s_cmp_eq_u64 vcc, -1
    s_cbranch_scc1 FE_WL_OK
    s_sub_u32 s90, s90, 1
    s_cmp_lg_u32 s90, 0
    s_cbranch_scc1 FE_WL
FE_WL_OK:
    s_add_u32 s76, s2, 0
    s_cmp_lg_u32 s2, 255
    s_cbranch_scc1 FE_NOZERO
    s_cmp_lg_u32 s62, 5
    s_cbranch_scc1 FE_NOZERO
    v_mov_b32 v12, 0
    v_mov_b32 v120, 0
    v_mov_b32 v121, 0
    v_mov_b32 v122, 0
    v_mov_b32 v123, 0
    v_and_b32 v124, 63, v0
    v_lshlrev_b32 v124, 4, v124
    s_mov_b32 s68, 32768
    buffer_store_dwordx4 v[120:123], v124, s[28:31], s68 offen sc1
    s_add_u32 s68, s68, 1024
    buffer_store_dwordx4 v[120:123], v124, s[28:31], s68 offen sc1
    s_add_u32 s68, s68, 1024
    buffer_store_dwordx4 v[120:123], v124, s[28:31], s68 offen sc1
    s_add_u32 s68, s68, 1024
    buffer_store_dwordx4 v[120:123], v124, s[28:31], s68 offen sc1
    s_add_u32 s68, s68, 1024
    buffer_store_dwordx4 v[120:123], v124, s[28:31], s68 offen sc1
    s_add_u32 s68, s68, 1024
    buffer_store_dwordx4 v[120:123], v124, s[28:31], s68 offen sc1
    s_add_u32 s68, s68, 1024
    buffer_store_dwordx4 v[120:123], v124, s[28:31], s68 offen sc1
    s_add_u32 s68, s68, 1024
    buffer_store_dwordx4 v[120:123], v124, s[28:31], s68 offen sc1
    s_add_u32 s68, s68, 1024
    buffer_store_dwordx4 v[120:123], v124, s[28:31], s68 offen sc1
    s_add_u32 s68, s68, 1024
    buffer_store_dwordx4 v[120:123], v124, s[28:31], s68 offen sc1
    s_add_u32 s68, s68, 1024
    buffer_store_dwordx4 v[120:123], v124, s[28:31], s68 offen sc1
    s_add_u32 s68, s68, 1024
    buffer_store_dwordx4 v[120:123], v124, s[28:31], s68 offen sc1
    s_add_u32 s68, s68, 1024
    buffer_store_dwordx4 v[120:123], v124, s[28:31], s68 offen sc1
    s_add_u32 s68, s68, 1024
    buffer_store_dwordx4 v[120:123], v124, s[28:31], s68 offen sc1
    s_add_u32 s68, s68, 1024
    buffer_store_dwordx4 v[120:123], v124, s[28:31], s68 offen sc1
    s_add_u32 s68, s68, 1024
    buffer_store_dwordx4 v[120:123], v124, s[28:31], s68 offen sc1
    s_add_u32 s68, s68, 1024
    buffer_store_dwordx4 v[120:123], v124, s[28:31], s68 offen sc1
    s_add_u32 s68, s68, 1024
    buffer_store_dwordx4 v[120:123], v124, s[28:31], s68 offen sc1
    s_add_u32 s68, s68, 1024
    buffer_store_dwordx4 v[120:123], v124, s[28:31], s68 offen sc1
    s_add_u32 s68, s68, 1024
    buffer_store_dwordx4 v[120:123], v124, s[28:31], s68 offen sc1
    s_add_u32 s68, s68, 1024
    buffer_store_dwordx4 v[120:123], v124, s[28:31], s68 offen sc1
    s_add_u32 s68, s68, 1024
    buffer_store_dwordx4 v[120:123], v124, s[28:31], s68 offen sc1
    s_add_u32 s68, s68, 1024
    buffer_store_dwordx4 v[120:123], v124, s[28:31], s68 offen sc1
    s_add_u32 s68, s68, 1024
    buffer_store_dwordx4 v[120:123], v124, s[28:31], s68 offen sc1
    s_add_u32 s68, s68, 1024
    s_waitcnt vmcnt(0)
    v_mov_b32 v10, 1
    s_mov_b64 exec, 1
    buffer_store_dword v10, v12, s[24:27], 0 offen offset:8 sc1
    s_mov_b64 exec, -1
FE_NOZERO:
    buffer_load_dwordx4 v[176:179], v93, s[36:39], s77 offen
    s_add_u32 s77, s77, 12288
    buffer_load_dwordx4 v[180:183], v93, s[36:39], s77 offen
    s_add_u32 s77, s77, 86016
    buffer_load_dwordx4 v[184:187], v93, s[36:39], s77 offen
    s_add_u32 s77, s77, 12288
    buffer_load_dwordx4 v[188:191], v93, s[36:39], s77 offen
    s_add_u32 s77, s77, 86016
    buffer_load_dwordx4 v[192:195], v93, s[36:39], s77 offen
    s_add_u32 s77, s77, 12288
    buffer_load_dwordx4 v[196:199], v93, s[36:39], s77 offen
    s_add_u32 s77, s77, 86016
    buffer_load_dwordx4 v[200:203], v93, s[36:39], s77 offen
    s_add_u32 s77, s77, 12288
    buffer_load_dwordx4 v[204:207], v93, s[36:39], s77 offen
    s_add_u32 s77, s77, 86016
    buffer_load_dwordx4 v[208:211], v93, s[36:39], s77 offen
    s_add_u32 s77, s77, 12288
    buffer_load_dwordx4 v[212:215], v93, s[36:39], s77 offen
    s_add_u32 s77, s77, 86016
    buffer_load_dwordx4 v[216:219], v93, s[36:39], s77 offen
    s_add_u32 s77, s77, 12288
    buffer_load_dwordx4 v[220:223], v93, s[36:39], s77 offen
    s_add_u32 s77, s77, 86016
    buffer_load_dwordx4 v[224:227], v93, s[36:39], s77 offen
    s_add_u32 s77, s77, 12288
    buffer_load_dwordx4 v[228:231], v93, s[36:39], s77 offen
    s_add_u32 s77, s77, 86016
    buffer_load_dwordx4 v[232:235], v93, s[36:39], s77 offen
    s_add_u32 s77, s77, 12288
    buffer_load_dwordx4 v[236:239], v93, s[36:39], s77 offen
    s_add_u32 s77, s77, 86016
    s_waitcnt lgkmcnt(0)
    s_waitcnt vmcnt(14)
    v_perm_b32 v134, v180, v176, s78
    v_perm_b32 v135, v180, v176, s79
    v_dot2c_f32_bf16 v160, v134, v136
    v_dot2c_f32_bf16 v161, v135, v136
    v_perm_b32 v134, v181, v177, s78
    v_perm_b32 v135, v181, v177, s79
    v_dot2c_f32_bf16 v162, v134, v136
    v_dot2c_f32_bf16 v163, v135, v136
    v_perm_b32 v134, v182, v178, s78
    v_perm_b32 v135, v182, v178, s79
    v_dot2c_f32_bf16 v164, v134, v136
    v_dot2c_f32_bf16 v165, v135, v136
    v_perm_b32 v134, v183, v179, s78
    v_perm_b32 v135, v183, v179, s79
    v_dot2c_f32_bf16 v166, v134, v136
    v_dot2c_f32_bf16 v167, v135, v136
    s_waitcnt vmcnt(12)
    v_perm_b32 v134, v188, v184, s78
    v_perm_b32 v135, v188, v184, s79
    v_dot2c_f32_bf16 v160, v134, v137
    v_dot2c_f32_bf16 v161, v135, v137
    v_perm_b32 v134, v189, v185, s78
    v_perm_b32 v135, v189, v185, s79
    v_dot2c_f32_bf16 v162, v134, v137
    v_dot2c_f32_bf16 v163, v135, v137
    v_perm_b32 v134, v190, v186, s78
    v_perm_b32 v135, v190, v186, s79
    v_dot2c_f32_bf16 v164, v134, v137
    v_dot2c_f32_bf16 v165, v135, v137
    v_perm_b32 v134, v191, v187, s78
    v_perm_b32 v135, v191, v187, s79
    v_dot2c_f32_bf16 v166, v134, v137
    v_dot2c_f32_bf16 v167, v135, v137
    s_waitcnt vmcnt(10)
    v_perm_b32 v134, v196, v192, s78
    v_perm_b32 v135, v196, v192, s79
    v_dot2c_f32_bf16 v160, v134, v138
    v_dot2c_f32_bf16 v161, v135, v138
    v_perm_b32 v134, v197, v193, s78
    v_perm_b32 v135, v197, v193, s79
    v_dot2c_f32_bf16 v162, v134, v138
    v_dot2c_f32_bf16 v163, v135, v138
    v_perm_b32 v134, v198, v194, s78
    v_perm_b32 v135, v198, v194, s79
    v_dot2c_f32_bf16 v164, v134, v138
    v_dot2c_f32_bf16 v165, v135, v138
    v_perm_b32 v134, v199, v195, s78
    v_perm_b32 v135, v199, v195, s79
    v_dot2c_f32_bf16 v166, v134, v138
    v_dot2c_f32_bf16 v167, v135, v138
    s_waitcnt vmcnt(8)
    v_perm_b32 v134, v204, v200, s78
    v_perm_b32 v135, v204, v200, s79
    v_dot2c_f32_bf16 v160, v134, v139
    v_dot2c_f32_bf16 v161, v135, v139
    v_perm_b32 v134, v205, v201, s78
    v_perm_b32 v135, v205, v201, s79
    v_dot2c_f32_bf16 v162, v134, v139
    v_dot2c_f32_bf16 v163, v135, v139
    v_perm_b32 v134, v206, v202, s78
    v_perm_b32 v135, v206, v202, s79
    v_dot2c_f32_bf16 v164, v134, v139
    v_dot2c_f32_bf16 v165, v135, v139
    v_perm_b32 v134, v207, v203, s78
    v_perm_b32 v135, v207, v203, s79
    v_dot2c_f32_bf16 v166, v134, v139
    v_dot2c_f32_bf16 v167, v135, v139
    s_waitcnt vmcnt(6)
    v_perm_b32 v134, v212, v208, s78
    v_perm_b32 v135, v212, v208, s79
    v_dot2c_f32_bf16 v160, v134, v140
    v_dot2c_f32_bf16 v161, v135, v140
    v_perm_b32 v134, v213, v209, s78
    v_perm_b32 v135, v213, v209, s79
    v_dot2c_f32_bf16 v162, v134, v140
    v_dot2c_f32_bf16 v163, v135, v140
    v_perm_b32 v134, v214, v210, s78
    v_perm_b32 v135, v214, v210, s79
    v_dot2c_f32_bf16 v164, v134, v140
    v_dot2c_f32_bf16 v165, v135, v140
    v_perm_b32 v134, v215, v211, s78
    v_perm_b32 v135, v215, v211, s79
    v_dot2c_f32_bf16 v166, v134, v140
    v_dot2c_f32_bf16 v167, v135, v140
    s_waitcnt vmcnt(4)
    v_perm_b32 v134, v220, v216, s78
    v_perm_b32 v135, v220, v216, s79
    v_dot2c_f32_bf16 v160, v134, v141
    v_dot2c_f32_bf16 v161, v135, v141
    v_perm_b32 v134, v221, v217, s78
    v_perm_b32 v135, v221, v217, s79
    v_dot2c_f32_bf16 v162, v134, v141
    v_dot2c_f32_bf16 v163, v135, v141
    v_perm_b32 v134, v222, v218, s78
    v_perm_b32 v135, v222, v218, s79
    v_dot2c_f32_bf16 v164, v134, v141
    v_dot2c_f32_bf16 v165, v135, v141
    v_perm_b32 v134, v223, v219, s78
    v_perm_b32 v135, v223, v219, s79
    v_dot2c_f32_bf16 v166, v134, v141
    v_dot2c_f32_bf16 v167, v135, v141
    s_waitcnt vmcnt(2)
    v_perm_b32 v134, v228, v224, s78
    v_perm_b32 v135, v228, v224, s79
    v_dot2c_f32_bf16 v160, v134, v142
    v_dot2c_f32_bf16 v161, v135, v142
    v_perm_b32 v134, v229, v225, s78
    v_perm_b32 v135, v229, v225, s79
    v_dot2c_f32_bf16 v162, v134, v142
    v_dot2c_f32_bf16 v163, v135, v142
    v_perm_b32 v134, v230, v226, s78
    v_perm_b32 v135, v230, v226, s79
    v_dot2c_f32_bf16 v164, v134, v142
    v_dot2c_f32_bf16 v165, v135, v142
    v_perm_b32 v134, v231, v227, s78
    v_perm_b32 v135, v231, v227, s79
    v_dot2c_f32_bf16 v166, v134, v142
    v_dot2c_f32_bf16 v167, v135, v142
    s_waitcnt vmcnt(0)
    v_perm_b32 v134, v236, v232, s78
    v_perm_b32 v135, v236, v232, s79
    v_dot2c_f32_bf16 v160, v134, v143
    v_dot2c_f32_bf16 v161, v135, v143
    v_perm_b32 v134, v237, v233, s78
    v_perm_b32 v135, v237, v233, s79
    v_dot2c_f32_bf16 v162, v134, v143
    v_dot2c_f32_bf16 v163, v135, v143
    v_perm_b32 v134, v238, v234, s78
    v_perm_b32 v135, v238, v234, s79
    v_dot2c_f32_bf16 v164, v134, v143
    v_dot2c_f32_bf16 v165, v135, v143
    v_perm_b32 v134, v239, v235, s78
    v_perm_b32 v135, v239, v235, s79
    v_dot2c_f32_bf16 v166, v134, v143
    v_dot2c_f32_bf16 v167, v135, v143
    v_lshrrev_b32 v133, 4, v90
    v_lshlrev_b32 v133, 9, v133
    v_lshl_add_u32 v133, v95, 5, v133
    s_lshl_b32 s64, s65, 11
    s_add_u32 s64, s64, 72192
    v_add_u32 v133, s64, v133
    ds_write_b128 v133, v[160:163]
    ds_write_b128 v133, v[164:167] offset:16
    s_waitcnt lgkmcnt(0)
    v_mov_b32 v133, 80388
    v_mov_b32 v134, 1
    s_mov_b64 exec, 1
    ds_add_u32 v133, v134
    s_mov_b64 exec, -1
    v_mov_b32 v133, 80388
    s_mov_b32 s90, 1048576
FE_WB:
    ds_read_b32 v134, v133
    s_waitcnt lgkmcnt(0)
    v_cmp_eq_u32 vcc, 4, v134
    s_nop 1
    s_cmp_eq_u64 vcc, -1
    s_cbranch_scc1 FE_WB_OK
    s_sub_u32 s90, s90, 1
    s_cmp_lg_u32 s90, 0
    s_cbranch_scc1 FE_WB
FE_WB_OK:
    v_and_b32 v133, 31, v90
    v_lshlrev_b32 v133, 2, v133
    v_lshrrev_b32 v134, 5, v90
    v_lshl_add_u32 v134, v134, 12, v133
    s_lshl_b32 s64, s65, 7
    s_add_u32 s76, s64, 72192
    v_add_u32 v134, s76, v134
    ds_read_b32 v160, v134 offset:0
    ds_read_b32 v161, v134 offset:512
    ds_read_b32 v162, v134 offset:1024
    ds_read_b32 v163, v134 offset:1536
    ds_read_b32 v164, v134 offset:2048
    ds_read_b32 v165, v134 offset:2560
    ds_read_b32 v166, v134 offset:3072
    ds_read_b32 v167, v134 offset:3584
    s_waitcnt lgkmcnt(0)
    v_pk_add_f32 v[160:161], v[160:161], v[162:163]
    v_pk_add_f32 v[164:165], v[164:165], v[166:167]
    v_pk_add_f32 v[160:161], v[160:161], v[164:165]
    v_add_f32 v160, v160, v161
    v_mov_b32 v161, v160
    s_nop 1
    v_permlane32_swap_b32 v160, v161
    v_add_f32 v160, v160, v161
    s_lshl_b32 s77, s42, 9
    s_add_u32 s76, s77, s64
    s_add_u32 s76, s76, 32768
    s_cmp_ge_u32 s2, 192
    s_cbranch_scc1 FE_YB
    v_mov_b32 v134, 80412
    s_mov_b32 s90, 1048576
FE_WG:
    ds_read_b32 v135, v134
    s_waitcnt lgkmcnt(0)
    v_cmp_eq_u32 vcc, 1, v135
    s_nop 1
    s_cmp_eq_u64 vcc, -1
    s_cbranch_scc1 FE_WG_OK
    s_sub_u32 s90, s90, 1
    s_cmp_lg_u32 s90, 0
    s_cbranch_scc1 FE_WG
FE_WG_OK:
    s_mov_b32 s64, -1
    s_mov_b32 s65, 0
    s_mov_b64 exec, s[64:65]
    buffer_atomic_add_f32 v160, v133, s[28:31], s76 offen
    s_mov_b64 exec, -1
FE_YB:
FE_YJ:
    s_load_dwordx4 s[4:7], s[0:1], 56
    s_load_dwordx4 s[48:51], s[0:1], 104
    s_load_dwordx2 s[30:31], s[0:1], 72
    s_load_dwordx2 s[42:43], s[0:1], 0
    s_memrealtime s[46:47]
    v_lshrrev_b32 v1, 6, v0
    s_mov_b32 s63, 0xffff0000
    v_readfirstlane_b32 s62, v1
    v_and_b32 v2, 63, v0
    s_and_b32 s58, s2, 7
    s_lshr_b32 s59, s2, 3
    s_and_b32 s52, s58, 1
    s_lshl_b32 s52, s52, 2
    s_and_b32 s53, s59, 3
    s_add_u32 s52, s52, s53
    s_lshr_b32 s53, s58, 1
    s_lshl_b32 s53, s53, 3
    s_lshr_b32 s54, s59, 2
    s_add_u32 s53, s53, s54
    s_lshl_b32 s55, s52, 5
    s_add_u32 s55, s55, s53
    s_lshl_b32 s92, s55, 3
    s_add_u32 s92, s92, s62
    s_lshl_b32 s92, s92, 11
    v_mul_u32_u24 v7, 4682, v2
    v_lshrrev_b32 v7, 16, v7
    v_mul_u32_u24 v8, 14, v7
    v_sub_u32 v8, v2, v8
    s_lshl_b32 s56, s62, 2
    v_add_u32 v7, s56, v7
    v_mul_u32_u24 v7, 7168, v7
    v_lshl_add_u32 v7, v8, 4, v7
    s_mul_i32 s56, s53, 224
    v_add_u32 v3, s56, v7
    s_mul_i32 s58, s62, 960
    s_mov_b32 s40, 0xffffffff
    s_mov_b32 s41, 0x00ffffff
    v_lshlrev_b32 v4, 4, v2
    v_lshlrev_b32 v5, 4, v0
    v_lshlrev_b32 v6, 5, v0
    s_mul_i32 s60, s55, 16512
    s_waitcnt lgkmcnt(0)
    s_mov_b32 s28, s50
    s_mov_b32 s29, s51
    s_or_b32 s46, s46, 1
    s_add_u32 s64, s28, 1048576
    s_addc_u32 s65, s29, 0
    s_mov_b32 s66, 4227072
    s_mov_b32 s67, 0x00020000
    s_mov_b32 s72, s42
    s_mov_b32 s73, s43
    s_mov_b32 s74, 4194304
    s_mov_b32 s75, 0x00020000
    s_mov_b32 s80, s28
    s_mov_b32 s81, s29
    s_mov_b32 s82, 1048576
    s_mov_b32 s83, 0x00020000
    buffer_load_dwordx4 v[148:151], v4, s[72:75], s92 offen
    buffer_load_dwordx4 v[152:155], v4, s[72:75], s92 offen offset:1024
    s_mov_b32 s24, s48
    s_mov_b32 s25, s49
    s_mov_b32 s26, 256
    s_mov_b32 s27, 0x00020000
    s_mov_b32 s8, s4
    s_mov_b32 s9, s5
    s_mov_b32 s10, 7340032
    s_mov_b32 s11, 0x00020000
    s_mov_b32 s12, s6
    s_mov_b32 s13, s7
    s_mov_b32 s14, 7340032
    s_mov_b32 s15, 0x00020000
    s_add_u32 s16, s28, 10485760
    s_addc_u32 s17, s29, 0
    s_mov_b32 s18, 4194304
    s_mov_b32 s19, 0x00020000
    s_add_u32 s20, s28, 10485760
    s_addc_u32 s21, s29, 0
    s_mov_b32 s22, 4194304
    s_mov_b32 s23, 0x00020000
    s_mov_b32 s45, 0
    s_add_u32 s84, s28, 6291456
    s_addc_u32 s85, s29, 0
    s_mov_b32 s86, 4194304
    s_mov_b32 s87, 0x00020000
    s_mov_b32 s78, 0x05040100
    s_mov_b32 s79, 0x07060302
    s_waitcnt vmcnt(2)
    s_waitcnt lgkmcnt(0)
    v_mov_b32 v12, 80384
    v_mov_b32 v13, 1
    s_mov_b64 exec, 1
    ds_add_u32 v12, v13
    s_mov_b64 exec, -1
    v_mov_b32 v12, 80384
    s_mov_b32 s90, 1048576
F1_WFIN:
    ds_read_b32 v13, v12
    s_waitcnt lgkmcnt(0)
    v_cmp_eq_u32 vcc, 8, v13
    s_nop 1
    s_cmp_eq_u64 vcc, -1
    s_cbranch_scc1 F1_WFIN_OK
    s_sub_u32 s90, s90, 1
    s_cmp_lg_u32 s90, 0
    s_cbranch_scc1 F1_WFIN
F1_WFIN_OK:
    s_cmp_lg_u32 s62, 0
    s_cbranch_scc1 F1_NOFLAG
    v_and_b32 v12, 7, v0
    v_mul_u32_u24 v12, 2176, v12
    s_lshl_b32 s61, s2, 3
    s_add_u32 s61, s61, 69632
    s_mov_b64 exec, 0xff
    buffer_store_dwordx2 v[156:157], v12, s[80:83], s61 offen sc1
    s_mov_b64 exec, -1
    v_mov_b32 v116, v156
    v_mov_b32 v117, v157
F1_NOFLAG:
    s_add_u32 m0, s58, 0
    s_mov_b64 exec, s[40:41]
    buffer_load_dwordx4 v3, s[8:11], s45 offen lds
    s_mov_b64 exec, -1
    s_add_u32 m0, s58, 7680
    s_mov_b64 exec, s[40:41]
    buffer_load_dwordx4 v3, s[12:15], s45 offen lds
    s_mov_b64 exec, -1
    s_add_u32 s45, s45, 229376
    s_add_u32 m0, s58, 15360
    s_mov_b64 exec, s[40:41]
    buffer_load_dwordx4 v3, s[8:11], s45 offen lds
    s_mov_b64 exec, -1
    s_add_u32 m0, s58, 23040
    s_mov_b64 exec, s[40:41]
    buffer_load_dwordx4 v3, s[12:15], s45 offen lds
    s_mov_b64 exec, -1
    s_add_u32 s45, s45, 229376
    v_mov_b32 v102, 0x3a800000
    s_waitcnt vmcnt(4)
    v_lshlrev_b32 v64, 16, v148
    v_and_b32 v65, s63, v148
    v_lshlrev_b32 v66, 16, v149
    v_and_b32 v67, s63, v149
    v_lshlrev_b32 v68, 16, v150
    v_and_b32 v69, s63, v150
    v_lshlrev_b32 v70, 16, v151
    v_and_b32 v71, s63, v151
    v_lshlrev_b32 v72, 16, v152
    v_and_b32 v73, s63, v152
    v_lshlrev_b32 v74, 16, v153
    v_and_b32 v75, s63, v153
    v_lshlrev_b32 v76, 16, v154
    v_and_b32 v77, s63, v154
    v_lshlrev_b32 v78, 16, v155
    v_and_b32 v79, s63, v155
    v_pk_add_f32 v[96:97], v[64:65], v[66:67]
    v_pk_add_f32 v[98:99], v[68:69], v[70:71]
    v_pk_add_f32 v[96:97], v[96:97], v[72:73]
    v_pk_add_f32 v[98:99], v[98:99], v[74:75]
    v_pk_add_f32 v[96:97], v[96:97], v[76:77]
    v_pk_add_f32 v[98:99], v[98:99], v[78:79]
    v_pk_add_f32 v[96:97], v[96:97], v[98:99]
    v_add_f32 v96, v96, v97
    s_nop 1
    v_add_f32_dpp v96, v96, v96 row_shr:1 row_mask:0xf bank_mask:0xf
    s_nop 1
    v_add_f32_dpp v96, v96, v96 row_shr:2 row_mask:0xf bank_mask:0xf
    s_nop 1
    v_add_f32_dpp v96, v96, v96 row_shr:4 row_mask:0xf bank_mask:0xf
    s_nop 1
    v_add_f32_dpp v96, v96, v96 row_shr:8 row_mask:0xf bank_mask:0xf
    s_nop 1
    v_add_f32_dpp v96, v96, v96 row_bcast:15 row_mask:0xa bank_mask:0xf
    s_nop 1
    v_add_f32_dpp v96, v96, v96 row_bcast:31 row_mask:0xc bank_mask:0xf
    s_nop 0
    v_readlane_b32 s70, v96, 63
    s_nop 1
    v_mov_b32 v100, s70
    v_mul_f32 v100, 0xba800000, v100
    v_mov_b32 v101, v100
    v_pk_add_f32 v[80:81], v[64:65], v[100:101]
    v_pk_add_f32 v[82:83], v[66:67], v[100:101]
    v_pk_add_f32 v[84:85], v[68:69], v[100:101]
    v_pk_add_f32 v[86:87], v[70:71], v[100:101]
    v_pk_add_f32 v[88:89], v[72:73], v[100:101]
    v_pk_add_f32 v[90:91], v[74:75], v[100:101]
    v_pk_add_f32 v[92:93], v[76:77], v[100:101]
    v_pk_add_f32 v[94:95], v[78:79], v[100:101]
    v_pk_mul_f32 v[96:97], v[80:81], v[80:81]
    v_pk_mul_f32 v[98:99], v[82:83], v[82:83]
    v_pk_fma_f32 v[96:97], v[84:85], v[84:85], v[96:97]
    v_pk_fma_f32 v[98:99], v[86:87], v[86:87], v[98:99]
    v_pk_fma_f32 v[96:97], v[88:89], v[88:89], v[96:97]
    v_pk_fma_f32 v[98:99], v[90:91], v[90:91], v[98:99]
    v_pk_fma_f32 v[96:97], v[92:93], v[92:93], v[96:97]
    v_pk_fma_f32 v[98:99], v[94:95], v[94:95], v[98:99]
    v_pk_add_f32 v[96:97], v[96:97], v[98:99]
    v_add_f32 v96, v96, v97
    s_nop 1
    v_add_f32_dpp v96, v96, v96 row_shr:1 row_mask:0xf bank_mask:0xf
    s_nop 1
    v_add_f32_dpp v96, v96, v96 row_shr:2 row_mask:0xf bank_mask:0xf
    s_nop 1
    v_add_f32_dpp v96, v96, v96 row_shr:4 row_mask:0xf bank_mask:0xf
    s_nop 1
    v_add_f32_dpp v96, v96, v96 row_shr:8 row_mask:0xf bank_mask:0xf
    s_nop 1
    v_add_f32_dpp v96, v96, v96 row_bcast:15 row_mask:0xa bank_mask:0xf
    s_nop 1
    v_add_f32_dpp v96, v96, v96 row_bcast:31 row_mask:0xc bank_mask:0xf
    s_nop 0
    v_readlane_b32 s71, v96, 63
    s_nop 1
    v_mov_b32 v100, s71
    v_fmaak_f32 v100, v100, v102, 0x3727c5ac
    v_rsq_f32 v100, v100
    s_nop 0
    v_mov_b32 v101, v100
    v_pk_mul_f32 v[80:81], v[80:81], v[100:101]
    v_pk_mul_f32 v[82:83], v[82:83], v[100:101]
    v_pk_mul_f32 v[84:85], v[84:85], v[100:101]
    v_pk_mul_f32 v[86:87], v[86:87], v[100:101]
    v_pk_mul_f32 v[88:89], v[88:89], v[100:101]
    v_pk_mul_f32 v[90:91], v[90:91], v[100:101]
    v_pk_mul_f32 v[92:93], v[92:93], v[100:101]
    v_pk_mul_f32 v[94:95], v[94:95], v[100:101]
    s_cmp_lt_u32 s62, 4
    s_cbranch_scc1 F1_NOPF
    s_mov_b32 s32, s30
    s_mov_b32 s33, s31
    s_mov_b32 s34, 7340032
    s_mov_b32 s35, 0x00020000
    s_sub_u32 s57, s62, 4
    s_mul_i32 s57, s57, 7
    s_mul_i32 s61, s2, 28672
    s_lshl_b32 s56, s57, 10
    s_add_u32 s61, s61, s56
    buffer_load_dwordx4 v[176:179], v4, s[32:35], s61 offen offset:0
    buffer_load_dwordx4 v[180:183], v4, s[32:35], s61 offen offset:1024
    buffer_load_dwordx4 v[184:187], v4, s[32:35], s61 offen offset:2048
    buffer_load_dwordx4 v[188:191], v4, s[32:35], s61 offen offset:3072
    s_add_u32 s61, s61, 4096
    buffer_load_dwordx4 v[192:195], v4, s[32:35], s61 offen offset:0
    buffer_load_dwordx4 v[196:199], v4, s[32:35], s61 offen offset:1024
    buffer_load_dwordx4 v[200:203], v4, s[32:35], s61 offen offset:2048
    s_cmp_lt_u32 s2, 128
    s_cselect_b32 s36, s4, s6
    s_cselect_b32 s37, s5, s7
    s_mov_b32 s38, 2293760
    s_mov_b32 s39, 0x00020000
    s_and_b32 s61, s2, 127
    s_mul_i32 s61, s61, 17920
    s_sub_u32 s56, s62, 4
    s_mul_i32 s56, s56, 4480
    s_add_u32 s61, s61, s56
    buffer_load_dwordx4 v[208:211], v4, s[36:39], s61 offen offset:0
    buffer_load_dwordx4 v[212:215], v4, s[36:39], s61 offen offset:1024
    buffer_load_dwordx4 v[216:219], v4, s[36:39], s61 offen offset:2048
    buffer_load_dwordx4 v[220:223], v4, s[36:39], s61 offen offset:3072
    s_add_u32 s61, s61, 4096
    buffer_load_dwordx4 v[224:227], v4, s[36:39], s61 offen offset:0
F1_NOPF:
    s_cmp_lg_u32 s62, 0
    s_cbranch_scc1 F1_S1_SKIP
    v_and_b32 v12, 63, v0
    v_lshlrev_b32 v12, 5, v12
    s_and_b32 s61, s2, 7
    s_mul_i32 s61, s61, 2176
    s_add_u32 s61, s61, 69632
    s_mov_b32 s90, 65536
F1_P1:
    buffer_load_dwordx4 v[16:19], v12, s[80:83], s61 offen sc1
    buffer_load_dwordx4 v[20:23], v12, s[80:83], s61 offen offset:16 sc1
    s_waitcnt vmcnt(0)
    v_cmp_eq_u64 vcc, v[16:17], v[116:117]
    v_cmp_eq_u64 s[56:57], v[18:19], v[116:117]
    v_cmp_eq_u64 s[88:89], v[20:21], v[116:117]
    v_cmp_eq_u64 s[76:77], v[22:23], v[116:117]
    s_and_b64 vcc, vcc, s[56:57]
    s_nop 0
    s_and_b64 s[88:89], s[88:89], s[76:77]
    s_and_b64 vcc, vcc, s[88:89]
    s_cmp_eq_u64 vcc, -1
    s_cbranch_scc1 F1_P1_OK
    s_sleep 0
    s_sub_u32 s90, s90, 1
    s_cmp_lg_u32 s90, 0
    s_cbranch_scc1 F1_P1
F1_P1_OK:
F1_S1_SKIP:
    s_barrier
    buffer_load_dwordx4 v[8:11], v6, s[64:67], s60 offen sc1
    buffer_load_dwordx4 v[12:15], v6, s[64:67], s60 offen offset:16 sc1
    s_mov_b32 s61, 32768
    buffer_load_dwordx4 v[16:19], v5, s[80:83], s61 offen sc1
    s_mov_b32 s61, 40960
    buffer_load_dwordx4 v[20:23], v5, s[80:83], s61 offen sc1
    s_mov_b32 s61, 49152
    buffer_load_dwordx4 v[24:27], v5, s[80:83], s61 offen sc1
    v_mov_b32 v102, 0x3a800000
    v_lshlrev_b32 v6, 2, v0
    v_add_u32 v6, 92160, v6
    v_lshlrev_b32 v7, 3, v0
    v_add_u32 v7, 92160, v7
    s_waitcnt vmcnt(3)
    v_perm_b32 v104, v12, v8, s78
    ds_write_b32 v6, v104 offset:0
    v_perm_b32 v105, v12, v8, s79
    ds_write_b32 v6, v105 offset:2048
    v_perm_b32 v106, v13, v9, s78
    ds_write_b32 v6, v106 offset:4096
    v_perm_b32 v107, v13, v9, s79
    ds_write_b32 v6, v107 offset:6144
    v_perm_b32 v108, v14, v10, s78
    ds_write_b32 v6, v108 offset:8192
    v_perm_b32 v109, v14, v10, s79
    ds_write_b32 v6, v109 offset:10240
    v_perm_b32 v110, v15, v11, s78
    ds_write_b32 v6, v110 offset:12288
    v_perm_b32 v111, v15, v11, s79
    ds_write_b32 v6, v111 offset:14336
    s_waitcnt vmcnt(0)
    s_cmp_ge_u32 s62, 4
    s_cbranch_scc1 K3_M3
    v_cvt_pk_bf16_f32 v16, v16, v17
    v_cvt_pk_bf16_f32 v17, v18, v19
    v_cvt_pk_bf16_f32 v24, v24, v25
    v_cvt_pk_bf16_f32 v25, v26, v27
    v_lshlrev_b32 v112, 16, v24
    v_and_b32 v113, s63, v24
    v_lshlrev_b32 v114, 16, v25
    v_and_b32 v115, s63, v25
    v_add_f32 v112, 1.0, v112
    v_add_f32 v113, 1.0, v113
    v_add_f32 v114, 1.0, v114
    v_add_f32 v115, 1.0, v115
    v_cvt_pk_bf16_f32 v24, v112, v113
    v_cvt_pk_bf16_f32 v25, v114, v115
    ds_write_b64 v7, v[24:25] offset:40960
    s_branch K3_M4
K3_M3:
    v_cvt_pk_bf16_f32 v16, v16, v17
    v_cvt_pk_bf16_f32 v17, v18, v19
    v_lshlrev_b32 v112, 16, v16
    v_and_b32 v113, s63, v16
    v_lshlrev_b32 v114, 16, v17
    v_and_b32 v115, s63, v17
    v_add_f32 v112, 1.0, v112
    v_add_f32 v113, 1.0, v113
    v_add_f32 v114, 1.0, v114
    v_add_f32 v115, 1.0, v115
    v_cvt_pk_bf16_f32 v16, v112, v113
    v_cvt_pk_bf16_f32 v17, v114, v115
K3_M4:
    v_cvt_pk_bf16_f32 v20, v20, v21
    v_cvt_pk_bf16_f32 v21, v22, v23
    ds_write_b64 v7, v[16:17] offset:32768
    ds_write_b64 v7, v[20:21] offset:36864
    v_add_u32 v4, 92160, v4
    s_lshl_b32 s64, s62, 11
    v_add_u32 v5, s64, v4
    s_waitcnt lgkmcnt(0)
    s_barrier
    ds_read_b128 v[8:11], v5 offset:0
    ds_read_b128 v[12:15], v5 offset:1024
    ds_read_b128 v[24:27], v4 offset:32768
    ds_read_b128 v[28:31], v4 offset:33792
    ds_read_b128 v[32:35], v4 offset:34816
    ds_read_b128 v[36:39], v4 offset:35840
    ds_read_b128 v[40:43], v4 offset:36864
    ds_read_b128 v[44:47], v4 offset:37888
    ds_read_b128 v[48:51], v4 offset:38912
    ds_read_b128 v[52:55], v4 offset:39936
    ds_read_b128 v[56:59], v4 offset:40960
    ds_read_b128 v[60:63], v4 offset:41984
    v_subrev_u32 v4, 92160, v4
    s_waitcnt lgkmcnt(6)
    v_lshlrev_b32 v128, 16, v32
    v_and_b32 v129, s63, v32
    v_lshlrev_b32 v130, 16, v33
    v_and_b32 v131, s63, v33
    v_lshlrev_b32 v132, 16, v34
    v_and_b32 v133, s63, v34
    v_lshlrev_b32 v134, 16, v35
    v_and_b32 v135, s63, v35
    v_lshlrev_b32 v136, 16, v36
    v_and_b32 v137, s63, v36
    v_lshlrev_b32 v138, 16, v37
    v_and_b32 v139, s63, v37
    v_lshlrev_b32 v140, 16, v38
    v_and_b32 v141, s63, v38
    v_lshlrev_b32 v142, 16, v39
    v_and_b32 v143, s63, v39
    v_lshlrev_b32 v160, 16, v24
    v_and_b32 v161, s63, v24
    v_lshlrev_b32 v162, 16, v25
    v_and_b32 v163, s63, v25
    v_lshlrev_b32 v164, 16, v26
    v_and_b32 v165, s63, v26
    v_lshlrev_b32 v166, 16, v27
    v_and_b32 v167, s63, v27
    v_lshlrev_b32 v168, 16, v28
    v_and_b32 v169, s63, v28
    v_lshlrev_b32 v170, 16, v29
    v_and_b32 v171, s63, v29
    v_lshlrev_b32 v172, 16, v30
    v_and_b32 v173, s63, v30
    v_lshlrev_b32 v174, 16, v31
    v_and_b32 v175, s63, v31
    v_pk_fma_f32 v[80:81], v[80:81], v[128:129], v[160:161]
    v_pk_fma_f32 v[82:83], v[82:83], v[130:131], v[162:163]
    v_pk_fma_f32 v[84:85], v[84:85], v[132:133], v[164:165]
    v_pk_fma_f32 v[86:87], v[86:87], v[134:135], v[166:167]
    v_pk_fma_f32 v[88:89], v[88:89], v[136:137], v[168:169]
    v_pk_fma_f32 v[90:91], v[90:91], v[138:139], v[170:171]
    v_pk_fma_f32 v[92:93], v[92:93], v[140:141], v[172:173]
    v_pk_fma_f32 v[94:95], v[94:95], v[142:143], v[174:175]
    s_waitcnt lgkmcnt(0)
    v_lshlrev_b32 v160, 16, v40
    v_and_b32 v161, s63, v40
    v_lshlrev_b32 v162, 16, v41
    v_and_b32 v163, s63, v41
    v_lshlrev_b32 v164, 16, v42
    v_and_b32 v165, s63, v42
    v_lshlrev_b32 v166, 16, v43
    v_and_b32 v167, s63, v43
    v_lshlrev_b32 v168, 16, v44
    v_and_b32 v169, s63, v44
    v_lshlrev_b32 v170, 16, v45
    v_and_b32 v171, s63, v45
    v_lshlrev_b32 v172, 16, v46
    v_and_b32 v173, s63, v46
    v_lshlrev_b32 v174, 16, v47
    v_and_b32 v175, s63, v47
    v_lshlrev_b32 v128, 16, v8
    v_and_b32 v129, s63, v8
    v_lshlrev_b32 v130, 16, v9
    v_and_b32 v131, s63, v9
    v_lshlrev_b32 v132, 16, v10
    v_and_b32 v133, s63, v10
    v_lshlrev_b32 v134, 16, v11
    v_and_b32 v135, s63, v11
    v_lshlrev_b32 v136, 16, v12
    v_and_b32 v137, s63, v12
    v_lshlrev_b32 v138, 16, v13
    v_and_b32 v139, s63, v13
    v_lshlrev_b32 v140, 16, v14
    v_and_b32 v141, s63, v14
    v_lshlrev_b32 v142, 16, v15
    v_and_b32 v143, s63, v15
    v_pk_mul_f32 v[80:81], v[80:81], v[128:129]
    v_pk_mul_f32 v[82:83], v[82:83], v[130:131]
    v_pk_mul_f32 v[84:85], v[84:85], v[132:133]
    v_pk_mul_f32 v[86:87], v[86:87], v[134:135]
    v_pk_mul_f32 v[88:89], v[88:89], v[136:137]
    v_pk_mul_f32 v[90:91], v[90:91], v[138:139]
    v_pk_mul_f32 v[92:93], v[92:93], v[140:141]
    v_pk_mul_f32 v[94:95], v[94:95], v[142:143]
    v_pk_fma_f32 v[64:65], v[80:81], v[160:161], v[64:65]
    v_pk_fma_f32 v[66:67], v[82:83], v[162:163], v[66:67]
    v_pk_fma_f32 v[68:69], v[84:85], v[164:165], v[68:69]
    v_pk_fma_f32 v[70:71], v[86:87], v[166:167], v[70:71]
    v_pk_fma_f32 v[72:73], v[88:89], v[168:169], v[72:73]
    v_pk_fma_f32 v[74:75], v[90:91], v[170:171], v[74:75]
    v_pk_fma_f32 v[76:77], v[92:93], v[172:173], v[76:77]
    v_pk_fma_f32 v[78:79], v[94:95], v[174:175], v[78:79]
    v_cvt_pk_bf16_f32 v8, v64, v65
    v_cvt_pk_bf16_f32 v9, v66, v67
    v_cvt_pk_bf16_f32 v10, v68, v69
    v_cvt_pk_bf16_f32 v11, v70, v71
    v_cvt_pk_bf16_f32 v12, v72, v73
    v_cvt_pk_bf16_f32 v13, v74, v75
    v_cvt_pk_bf16_f32 v14, v76, v77
    v_cvt_pk_bf16_f32 v15, v78, v79
    v_lshlrev_b32 v64, 16, v8
    v_and_b32 v65, s63, v8
    v_lshlrev_b32 v66, 16, v9
    v_and_b32 v67, s63, v9
    v_lshlrev_b32 v68, 16, v10
    v_and_b32 v69, s63, v10
    v_lshlrev_b32 v70, 16, v11
    v_and_b32 v71, s63, v11
    v_lshlrev_b32 v72, 16, v12
    v_and_b32 v73, s63, v12
    v_lshlrev_b32 v74, 16, v13
    v_and_b32 v75, s63, v13
    v_lshlrev_b32 v76, 16, v14
    v_and_b32 v77, s63, v14
    v_lshlrev_b32 v78, 16, v15
    v_and_b32 v79, s63, v15
    buffer_store_dwordx4 v[8:11], v4, s[84:87], s92 offen sc1
    buffer_store_dwordx4 v[12:15], v4, s[84:87], s92 offen offset:1024 sc1
    v_pk_add_f32 v[96:97], v[64:65], v[66:67]
    v_pk_add_f32 v[98:99], v[68:69], v[70:71]
    v_pk_add_f32 v[96:97], v[96:97], v[72:73]
    v_pk_add_f32 v[98:99], v[98:99], v[74:75]
    v_pk_add_f32 v[96:97], v[96:97], v[76:77]
    v_pk_add_f32 v[98:99], v[98:99], v[78:79]
    v_pk_add_f32 v[96:97], v[96:97], v[98:99]
    v_add_f32 v96, v96, v97
    s_nop 1
    v_add_f32_dpp v96, v96, v96 row_shr:1 row_mask:0xf bank_mask:0xf
    s_nop 1
    v_add_f32_dpp v96, v96, v96 row_shr:2 row_mask:0xf bank_mask:0xf
    s_nop 1
    v_add_f32_dpp v96, v96, v96 row_shr:4 row_mask:0xf bank_mask:0xf
    s_nop 1
    v_add_f32_dpp v96, v96, v96 row_shr:8 row_mask:0xf bank_mask:0xf
    s_nop 1
    v_add_f32_dpp v96, v96, v96 row_bcast:15 row_mask:0xa bank_mask:0xf
    s_nop 1
    v_add_f32_dpp v96, v96, v96 row_bcast:31 row_mask:0xc bank_mask:0xf
    s_nop 0
    v_readlane_b32 s70, v96, 63
    s_nop 1
    v_mov_b32 v100, s70
    v_mul_f32 v100, 0xba800000, v100
    v_mov_b32 v101, v100
    v_pk_add_f32 v[80:81], v[64:65], v[100:101]
    v_pk_add_f32 v[82:83], v[66:67], v[100:101]
    v_pk_add_f32 v[84:85], v[68:69], v[100:101]
    v_pk_add_f32 v[86:87], v[70:71], v[100:101]
    v_pk_add_f32 v[88:89], v[72:73], v[100:101]
    v_pk_add_f32 v[90:91], v[74:75], v[100:101]
    v_pk_add_f32 v[92:93], v[76:77], v[100:101]
    v_pk_add_f32 v[94:95], v[78:79], v[100:101]
    v_pk_mul_f32 v[96:97], v[80:81], v[80:81]
    v_pk_mul_f32 v[98:99], v[82:83], v[82:83]
    v_pk_fma_f32 v[96:97], v[84:85], v[84:85], v[96:97]
    v_pk_fma_f32 v[98:99], v[86:87], v[86:87], v[98:99]
    v_pk_fma_f32 v[96:97], v[88:89], v[88:89], v[96:97]
    v_pk_fma_f32 v[98:99], v[90:91], v[90:91], v[98:99]
    v_pk_fma_f32 v[96:97], v[92:93], v[92:93], v[96:97]
    v_pk_fma_f32 v[98:99], v[94:95], v[94:95], v[98:99]
    v_pk_add_f32 v[96:97], v[96:97], v[98:99]
    v_add_f32 v96, v96, v97
    s_nop 1
    v_add_f32_dpp v96, v96, v96 row_shr:1 row_mask:0xf bank_mask:0xf
    s_nop 1
    v_add_f32_dpp v96, v96, v96 row_shr:2 row_mask:0xf bank_mask:0xf
    s_nop 1
    v_add_f32_dpp v96, v96, v96 row_shr:4 row_mask:0xf bank_mask:0xf
    s_nop 1
    v_add_f32_dpp v96, v96, v96 row_shr:8 row_mask:0xf bank_mask:0xf
    s_nop 1
    v_add_f32_dpp v96, v96, v96 row_bcast:15 row_mask:0xa bank_mask:0xf
    s_nop 1
    v_add_f32_dpp v96, v96, v96 row_bcast:31 row_mask:0xc bank_mask:0xf
    s_nop 0
    v_readlane_b32 s71, v96, 63
    s_nop 1
    v_mov_b32 v100, s71
    v_fmaak_f32 v100, v100, v102, 0x3727c5ac
    v_rsq_f32 v100, v100
    s_nop 0
    v_mov_b32 v101, v100
    v_pk_mul_f32 v[80:81], v[80:81], v[100:101]
    v_pk_mul_f32 v[82:83], v[82:83], v[100:101]
    v_pk_mul_f32 v[84:85], v[84:85], v[100:101]
    v_pk_mul_f32 v[86:87], v[86:87], v[100:101]
    v_pk_mul_f32 v[88:89], v[88:89], v[100:101]
    v_pk_mul_f32 v[90:91], v[90:91], v[100:101]
    v_pk_mul_f32 v[92:93], v[92:93], v[100:101]
    v_pk_mul_f32 v[94:95], v[94:95], v[100:101]
    v_lshlrev_b32 v128, 16, v56
    v_and_b32 v129, s63, v56
    v_lshlrev_b32 v130, 16, v57
    v_and_b32 v131, s63, v57
    v_lshlrev_b32 v132, 16, v58
    v_and_b32 v133, s63, v58
    v_lshlrev_b32 v134, 16, v59
    v_and_b32 v135, s63, v59
    v_lshlrev_b32 v136, 16, v60
    v_and_b32 v137, s63, v60
    v_lshlrev_b32 v138, 16, v61
    v_and_b32 v139, s63, v61
    v_lshlrev_b32 v140, 16, v62
    v_and_b32 v141, s63, v62
    v_lshlrev_b32 v142, 16, v63
    v_and_b32 v143, s63, v63
    v_lshlrev_b32 v160, 16, v48
    v_and_b32 v161, s63, v48
    v_lshlrev_b32 v162, 16, v49
    v_and_b32 v163, s63, v49
    v_lshlrev_b32 v164, 16, v50
    v_and_b32 v165, s63, v50
    v_lshlrev_b32 v166, 16, v51
    v_and_b32 v167, s63, v51
    v_lshlrev_b32 v168, 16, v52
    v_and_b32 v169, s63, v52
    v_lshlrev_b32 v170, 16, v53
    v_and_b32 v171, s63, v53
    v_lshlrev_b32 v172, 16, v54
    v_and_b32 v173, s63, v54
    v_lshlrev_b32 v174, 16, v55
    v_and_b32 v175, s63, v55
    v_pk_fma_f32 v[80:81], v[80:81], v[128:129], v[160:161]
    v_pk_fma_f32 v[82:83], v[82:83], v[130:131], v[162:163]
    v_pk_fma_f32 v[84:85], v[84:85], v[132:133], v[164:165]
    v_pk_fma_f32 v[86:87], v[86:87], v[134:135], v[166:167]
    v_pk_fma_f32 v[88:89], v[88:89], v[136:137], v[168:169]
    v_pk_fma_f32 v[90:91], v[90:91], v[138:139], v[170:171]
    v_pk_fma_f32 v[92:93], v[92:93], v[140:141], v[172:173]
    v_pk_fma_f32 v[94:95], v[94:95], v[142:143], v[174:175]
    v_cvt_pk_bf16_f32 v16, v80, v81
    v_cvt_pk_bf16_f32 v17, v82, v83
    v_cvt_pk_bf16_f32 v18, v84, v85
    v_cvt_pk_bf16_f32 v19, v86, v87
    v_cvt_pk_bf16_f32 v20, v88, v89
    v_cvt_pk_bf16_f32 v21, v90, v91
    v_cvt_pk_bf16_f32 v22, v92, v93
    v_cvt_pk_bf16_f32 v23, v94, v95
    v_and_b32 v5, 7, v2
    v_xor_b32 v5, s62, v5
    v_lshlrev_b32 v5, 4, v5
    v_lshl_add_u32 v5, v2, 7, v5
    v_add_u32 v5, 92160, v5
    ds_write_b128 v5, v[16:19] offset:16384
    ds_write_b128 v5, v[20:23] offset:24576
    v_lshlrev_b32 v5, 4, v0
    v_add_u32 v5, 92160, v5
    v_lshrrev_b32 v6, 3, v0
    v_xor_b32 v7, v0, v6
    v_and_b32 v7, 7, v7
    v_lshlrev_b32 v7, 4, v7
    v_and_b32 v3, 3, v6
    v_lshl_add_u32 v7, v3, 8, v7
    v_lshrrev_b32 v3, 2, v6
    v_lshl_add_u32 v7, v3, 11, v7
    s_lshr_b32 s64, s55, 2
    s_lshl_b32 s64, s64, 16
    s_bfe_u32 s65, s55, 0x10001
    s_lshl_b32 s65, s65, 10
    s_add_u32 s64, s64, s65
    s_and_b32 s65, s55, 1
    s_lshl_b32 s65, s65, 7
    s_add_u32 s64, s64, s65
    s_add_u32 s65, s64, 32768
    s_waitcnt lgkmcnt(0)
    s_barrier
    ds_read_b128 v[16:19], v5 offset:16384
    ds_read_b128 v[20:23], v5 offset:24576
    s_waitcnt lgkmcnt(1)
    buffer_store_dwordx4 v[16:19], v7, s[16:19], s64 offen sc1
    s_waitcnt lgkmcnt(0)
    buffer_store_dwordx4 v[20:23], v7, s[16:19], s65 offen sc1
    v_mul_u32_u24 v7, 4682, v2
    v_lshrrev_b32 v7, 16, v7
    v_mul_u32_u24 v8, 14, v7
    v_sub_u32 v8, v2, v8
    s_lshl_b32 s56, s62, 2
    v_add_u32 v7, s56, v7
    v_mul_u32_u24 v7, 7168, v7
    v_lshl_add_u32 v7, v8, 4, v7
    s_mul_i32 s56, s53, 224
    v_add_u32 v3, s56, v7
    s_mul_i32 s58, s62, 960
    s_mov_b32 s40, 0xffffffff
    s_mov_b32 s41, 0x00ffffff
    s_cmp_eq_u32 s62, 0
    s_cbranch_scc1 K3_W0LATE
    s_mov_b32 s43, s45
    s_add_u32 m0, s58, 30720
    s_mov_b64 exec, s[40:41]
    buffer_load_dwordx4 v3, s[8:11], s45 offen lds
    s_mov_b64 exec, -1
    s_add_u32 m0, s58, 38400
    s_mov_b64 exec, s[40:41]
    buffer_load_dwordx4 v3, s[12:15], s45 offen lds
    s_mov_b64 exec, -1
    s_add_u32 s45, s45, 229376
    s_add_u32 m0, s58, 46080
    s_mov_b64 exec, s[40:41]
    buffer_load_dwordx4 v3, s[8:11], s45 offen lds
    s_mov_b64 exec, -1
    s_add_u32 m0, s58, 53760
    s_mov_b64 exec, s[40:41]
    buffer_load_dwordx4 v3, s[12:15], s45 offen lds
    s_mov_b64 exec, -1
    s_add_u32 s45, s45, 229376
    s_add_u32 m0, s58, 61440
    s_mov_b64 exec, s[40:41]
    buffer_load_dwordx4 v3, s[8:11], s45 offen lds
    s_mov_b64 exec, -1
    s_add_u32 m0, s58, 69120
    s_mov_b64 exec, s[40:41]
    buffer_load_dwordx4 v3, s[12:15], s45 offen lds
    s_mov_b64 exec, -1
    s_add_u32 s45, s45, 229376
    s_add_u32 m0, s58, 76800
    s_mov_b64 exec, s[40:41]
    buffer_load_dwordx4 v3, s[8:11], s45 offen lds
    s_mov_b64 exec, -1
    s_add_u32 m0, s58, 84480
    s_mov_b64 exec, s[40:41]
    buffer_load_dwordx4 v3, s[12:15], s45 offen lds
    s_mov_b64 exec, -1
    s_add_u32 s45, s45, 229376
    s_cmp_lg_u32 s62, 1
    s_cbranch_scc1 K3_NOT1
    s_mov_b32 s42, s45
    s_mov_b32 s45, s43
    v_subrev_u32 v3, 28672, v3
    s_sub_u32 s58, s58, 960
    s_add_u32 m0, s58, 30720
    s_mov_b64 exec, s[40:41]
    buffer_load_dwordx4 v3, s[8:11], s45 offen lds
    s_mov_b64 exec, -1
    s_add_u32 m0, s58, 38400
    s_mov_b64 exec, s[40:41]
    buffer_load_dwordx4 v3, s[12:15], s45 offen lds
    s_mov_b64 exec, -1
    s_add_u32 s45, s45, 229376
    s_add_u32 m0, s58, 46080
    s_mov_b64 exec, s[40:41]
    buffer_load_dwordx4 v3, s[8:11], s45 offen lds
    s_mov_b64 exec, -1
    s_add_u32 m0, s58, 53760
    s_mov_b64 exec, s[40:41]
    buffer_load_dwordx4 v3, s[12:15], s45 offen lds
    s_mov_b64 exec, -1
    s_add_u32 s45, s45, 229376
    s_add_u32 m0, s58, 61440
    s_mov_b64 exec, s[40:41]
    buffer_load_dwordx4 v3, s[8:11], s45 offen lds
    s_mov_b64 exec, -1
    s_add_u32 m0, s58, 69120
    s_mov_b64 exec, s[40:41]
    buffer_load_dwordx4 v3, s[12:15], s45 offen lds
    s_mov_b64 exec, -1
    s_add_u32 s45, s45, 229376
    s_add_u32 m0, s58, 76800
    s_mov_b64 exec, s[40:41]
    buffer_load_dwordx4 v3, s[8:11], s45 offen lds
    s_mov_b64 exec, -1
    s_add_u32 m0, s58, 84480
    s_mov_b64 exec, s[40:41]
    buffer_load_dwordx4 v3, s[12:15], s45 offen lds
    s_mov_b64 exec, -1
    s_add_u32 s45, s45, 229376
    v_add_u32 v3, 28672, v3
    s_add_u32 s58, s58, 960
    s_waitcnt vmcnt(16)
    s_branch K3_W0J
K3_NOT1:
    s_cmp_lt_u32 s62, 4
    s_cbranch_scc1 K3_NORS2
    s_add_u32 s36, s28, 41943040
    s_addc_u32 s37, s29, 0
    s_mov_b32 s38, 7340032
    s_mov_b32 s39, 0x00020000
    s_sub_u32 s57, s62, 4
    s_mul_i32 s57, s57, 7
    v_lshrrev_b32 v10, 3, v2
    s_mov_b32 s61, 458752
    v_mul_lo_u32 v10, s61, v10
    v_and_b32 v13, 7, v2
    v_lshl_add_u32 v10, v13, 4, v10
    s_add_u32 s74, s57, 0
    s_lshr_b32 s75, s74, 1
    s_mul_i32 s76, s2, 14
    s_add_u32 s75, s75, s76
    s_and_b32 s74, s74, 1
    s_lshl_b32 s74, s74, 3
    s_mul_i32 s74, s74, 458752
    s_lshl_b32 s76, s75, 7
    s_add_u32 s74, s74, s76
    s_bfe_u32 s76, s75, 0x10001
    s_bfe_u32 s77, s75, 0x10003
    s_lshl_b32 s77, s77, 1
    s_or_b32 s76, s76, s77
    s_lshl_b32 s76, s76, 5
    v_xor_b32 v13, s76, v10
    buffer_store_dwordx4 v[176:179], v13, s[36:39], s74 offen
    s_add_u32 s74, s57, 1
    s_lshr_b32 s75, s74, 1
    s_mul_i32 s76, s2, 14
    s_add_u32 s75, s75, s76
    s_and_b32 s74, s74, 1
    s_lshl_b32 s74, s74, 3
    s_mul_i32 s74, s74, 458752
    s_lshl_b32 s76, s75, 7
    s_add_u32 s74, s74, s76
    s_bfe_u32 s76, s75, 0x10001
    s_bfe_u32 s77, s75, 0x10003
    s_lshl_b32 s77, s77, 1
    s_or_b32 s76, s76, s77
    s_lshl_b32 s76, s76, 5
    v_xor_b32 v13, s76, v10
    buffer_store_dwordx4 v[180:183], v13, s[36:39], s74 offen
    s_add_u32 s74, s57, 2
    s_lshr_b32 s75, s74, 1
    s_mul_i32 s76, s2, 14
    s_add_u32 s75, s75, s76
    s_and_b32 s74, s74, 1
    s_lshl_b32 s74, s74, 3
    s_mul_i32 s74, s74, 458752
    s_lshl_b32 s76, s75, 7
    s_add_u32 s74, s74, s76
    s_bfe_u32 s76, s75, 0x10001
    s_bfe_u32 s77, s75, 0x10003
    s_lshl_b32 s77, s77, 1
    s_or_b32 s76, s76, s77
    s_lshl_b32 s76, s76, 5
    v_xor_b32 v13, s76, v10
    buffer_store_dwordx4 v[184:187], v13, s[36:39], s74 offen
    s_add_u32 s74, s57, 3
    s_lshr_b32 s75, s74, 1
    s_mul_i32 s76, s2, 14
    s_add_u32 s75, s75, s76
    s_and_b32 s74, s74, 1
    s_lshl_b32 s74, s74, 3
    s_mul_i32 s74, s74, 458752
    s_lshl_b32 s76, s75, 7
    s_add_u32 s74, s74, s76
    s_bfe_u32 s76, s75, 0x10001
    s_bfe_u32 s77, s75, 0x10003
    s_lshl_b32 s77, s77, 1
    s_or_b32 s76, s76, s77
    s_lshl_b32 s76, s76, 5
    v_xor_b32 v13, s76, v10
    buffer_store_dwordx4 v[188:191], v13, s[36:39], s74 offen
    s_add_u32 s74, s57, 4
    s_lshr_b32 s75, s74, 1
    s_mul_i32 s76, s2, 14
    s_add_u32 s75, s75, s76
    s_and_b32 s74, s74, 1
    s_lshl_b32 s74, s74, 3
    s_mul_i32 s74, s74, 458752
    s_lshl_b32 s76, s75, 7
    s_add_u32 s74, s74, s76
    s_bfe_u32 s76, s75, 0x10001
    s_bfe_u32 s77, s75, 0x10003
    s_lshl_b32 s77, s77, 1
    s_or_b32 s76, s76, s77
    s_lshl_b32 s76, s76, 5
    v_xor_b32 v13, s76, v10
    buffer_store_dwordx4 v[192:195], v13, s[36:39], s74 offen
    s_add_u32 s74, s57, 5
    s_lshr_b32 s75, s74, 1
    s_mul_i32 s76, s2, 14
    s_add_u32 s75, s75, s76
    s_and_b32 s74, s74, 1
    s_lshl_b32 s74, s74, 3
    s_mul_i32 s74, s74, 458752
    s_lshl_b32 s76, s75, 7
    s_add_u32 s74, s74, s76
    s_bfe_u32 s76, s75, 0x10001
    s_bfe_u32 s77, s75, 0x10003
    s_lshl_b32 s77, s77, 1
    s_or_b32 s76, s76, s77
    s_lshl_b32 s76, s76, 5
    v_xor_b32 v13, s76, v10
    buffer_store_dwordx4 v[196:199], v13, s[36:39], s74 offen
    s_add_u32 s74, s57, 6
    s_lshr_b32 s75, s74, 1
    s_mul_i32 s76, s2, 14
    s_add_u32 s75, s75, s76
    s_and_b32 s74, s74, 1
    s_lshl_b32 s74, s74, 3
    s_mul_i32 s74, s74, 458752
    s_lshl_b32 s76, s75, 7
    s_add_u32 s74, s74, s76
    s_bfe_u32 s76, s75, 0x10001
    s_bfe_u32 s77, s75, 0x10003
    s_lshl_b32 s77, s77, 1
    s_or_b32 s76, s76, s77
    s_lshl_b32 s76, s76, 5
    v_xor_b32 v13, s76, v10
    buffer_store_dwordx4 v[200:203], v13, s[36:39], s74 offen
    s_waitcnt vmcnt(15)
    s_branch K3_W0J
K3_NORS2:
    s_waitcnt vmcnt(8)
    s_branch K3_W0J
K3_W0LATE:
    s_waitcnt vmcnt(0)
K3_W0J:
    s_cmp_lg_u32 s62, 0
    s_cbranch_scc1 K3_NONP
    v_mov_b32 v30, 0
    v_cmp_ne_u32 vcc, 0, v116
    v_mov_b32 v28, v116
    v_mov_b32 v29, v117
    s_cmp_eq_u64 vcc, -1
    s_cbranch_scc1 K3_NONP
    s_mov_b32 s90, 65536
K3_PN:
    buffer_load_dwordx2 v[28:29], v30, s[24:27], 0 offen sc1
    s_waitcnt vmcnt(0)
    v_cmp_ne_u32 vcc, 0, v28
    s_nop 1
    s_cmp_eq_u64 vcc, -1
    s_cbranch_scc1 K3_PN_OK
    s_sleep 0
    s_sub_u32 s90, s90, 1
    s_cmp_lg_u32 s90, 0
    s_cbranch_scc1 K3_PN
K3_PN_OK:
K3_NONP:
    s_barrier
    s_cmp_lg_u32 s62, 0
    s_cbranch_scc1 K3_S2_SKIP
    s_lshl_b32 s64, s55, 3
    s_add_u32 s64, s64, 98304
    s_mov_b64 exec, 1
    buffer_store_dwordx2 v[28:29], v30, s[80:83], s64 offen sc1
    s_mov_b64 exec, -1
    v_and_b32 v30, 31, v0
    v_lshlrev_b32 v30, 3, v30
    s_lshl_b32 s64, s52, 8
    s_add_u32 s64, s64, 98304
    s_mov_b32 s90, 65536
K3_P2:
    buffer_load_dwordx2 v[26:27], v30, s[80:83], s64 offen sc1
    s_waitcnt vmcnt(0)
    v_cmp_eq_u64 vcc, v[26:27], v[28:29]
    s_nop 1
    s_cmp_eq_u64 vcc, -1
    s_cbranch_scc1 K3_P2_OK
    s_sleep 0
    s_sub_u32 s90, s90, 1
    s_cmp_lg_u32 s90, 0
    s_cbranch_scc1 K3_P2
K3_P2_OK:
    s_add_u32 s45, s45, 917504
K3_S2_SKIP:
    s_barrier
    s_lshl_b32 s56, s52, 3
    s_add_u32 s56, s56, s62
    s_lshl_b32 s57, s56, 16
    v_lshlrev_b32 v7, 4, v2
    v_add_u32 v4, s57, v7
    s_mov_b32 s44, 0
    buffer_load_dwordx4 v[64:67], v4, s[16:19], s44 offen sc1
    buffer_load_dwordx4 v[68:71], v4, s[16:19], s44 offen offset:1024 sc1
    s_add_u32 s44, s44, 2048
    buffer_load_dwordx4 v[72:75], v4, s[16:19], s44 offen sc1
    buffer_load_dwordx4 v[76:79], v4, s[16:19], s44 offen offset:1024 sc1
    s_add_u32 s44, s44, 2048
    buffer_load_dwordx4 v[80:83], v4, s[16:19], s44 offen sc1
    buffer_load_dwordx4 v[84:87], v4, s[16:19], s44 offen offset:1024 sc1
    s_add_u32 s44, s44, 2048
    v_lshrrev_b32 v7, 4, v2
    v_mul_u32_u24 v7, 1920, v7
    v_bfe_u32 v8, v2, 2, 2
    v_mul_u32_u24 v8, 224, v8
    v_add_u32 v7, v7, v8
    v_and_b32 v8, 3, v2
    v_lshl_add_u32 v5, v8, 3, v7
    v_add_u32 v6, 61440, v5
    s_add_u32 s24, s28, 19922944
    s_addc_u32 s25, s29, 0
    s_mov_b32 s26, 14680064
    s_mov_b32 s27, 0x00020000
    s_mov_b32 s32, s30
    s_mov_b32 s33, s31
    s_mov_b32 s34, 7340032
    s_mov_b32 s35, 0x00020000
    s_add_u32 s36, s28, 41943040
    s_addc_u32 s37, s29, 0
    s_mov_b32 s38, 7340032
    s_mov_b32 s39, 0x00020000
    s_mul_i32 s73, s2, 28672
    s_lshl_b32 s74, s62, 12
    s_add_u32 s73, s73, s74
    v_lshlrev_b32 v12, 4, v2
    v_lshrrev_b32 v10, 3, v2
    s_mov_b32 s74, 458752
    v_mul_lo_u32 v10, s74, v10
    v_and_b32 v13, 7, v2
    v_lshl_add_u32 v10, v13, 4, v10
    v_mov_b32 v128, 0
    v_mov_b32 v129, 0
    v_mov_b32 v130, 0
    v_mov_b32 v131, 0
    v_mov_b32 v132, 0
    v_mov_b32 v133, 0
    v_mov_b32 v134, 0
    v_mov_b32 v135, 0
    v_mov_b32 v136, 0
    v_mov_b32 v137, 0
    v_mov_b32 v138, 0
    v_mov_b32 v139, 0
    v_mov_b32 v140, 0
    v_mov_b32 v141, 0
    v_mov_b32 v142, 0
    v_mov_b32 v143, 0
    v_mov_b32 v144, 0
    v_mov_b32 v145, 0
    v_mov_b32 v146, 0
    v_mov_b32 v147, 0
    v_mov_b32 v148, 0
    v_mov_b32 v149, 0
    v_mov_b32 v150, 0
    v_mov_b32 v151, 0
    v_mov_b32 v152, 0
    v_mov_b32 v153, 0
    v_mov_b32 v154, 0
    v_mov_b32 v155, 0
    v_mov_b32 v156, 0
    v_mov_b32 v157, 0
    v_mov_b32 v158, 0
    v_mov_b32 v159, 0
    v_mov_b32 v160, 0
    v_mov_b32 v161, 0
    v_mov_b32 v162, 0
    v_mov_b32 v163, 0
    v_mov_b32 v164, 0
    v_mov_b32 v165, 0
    v_mov_b32 v166, 0
    v_mov_b32 v167, 0
    v_mov_b32 v168, 0
    v_mov_b32 v169, 0
    v_mov_b32 v170, 0
    v_mov_b32 v171, 0
    v_mov_b32 v172, 0
    v_mov_b32 v173, 0
    v_mov_b32 v174, 0
    v_mov_b32 v175, 0
    v_mov_b32 v176, 0
    v_mov_b32 v177, 0
    v_mov_b32 v178, 0
    v_mov_b32 v179, 0
    v_mov_b32 v180, 0
    v_mov_b32 v181, 0
    v_mov_b32 v182, 0
    v_mov_b32 v183, 0
    v_mov_b32 v184, 0
    v_mov_b32 v185, 0
    v_mov_b32 v186, 0
    v_mov_b32 v187, 0
    v_mov_b32 v188, 0
    v_mov_b32 v189, 0
    v_mov_b32 v190, 0
    v_mov_b32 v191, 0
    v_mov_b32 v192, 0
    v_mov_b32 v193, 0
    v_mov_b32 v194, 0
    v_mov_b32 v195, 0
    v_mov_b32 v196, 0
    v_mov_b32 v197, 0
    v_mov_b32 v198, 0
    v_mov_b32 v199, 0
    v_mov_b32 v200, 0
    v_mov_b32 v201, 0
    v_mov_b32 v202, 0
    v_mov_b32 v203, 0
    v_mov_b32 v204, 0
    v_mov_b32 v205, 0
    v_mov_b32 v206, 0
    v_mov_b32 v207, 0
    v_mov_b32 v208, 0
    v_mov_b32 v209, 0
    v_mov_b32 v210, 0
    v_mov_b32 v211, 0
    v_mov_b32 v212, 0
    v_mov_b32 v213, 0
    v_mov_b32 v214, 0
    v_mov_b32 v215, 0
    v_mov_b32 v216, 0
    v_mov_b32 v217, 0
    v_mov_b32 v218, 0
    v_mov_b32 v219, 0
    v_mov_b32 v220, 0
    v_mov_b32 v221, 0
    v_mov_b32 v222, 0
    v_mov_b32 v223, 0
    v_mov_b32 v224, 0
    v_mov_b32 v225, 0
    v_mov_b32 v226, 0
    v_mov_b32 v227, 0
    v_mov_b32 v228, 0
    v_mov_b32 v229, 0
    v_mov_b32 v230, 0
    v_mov_b32 v231, 0
    v_mov_b32 v232, 0
    v_mov_b32 v233, 0
    v_mov_b32 v234, 0
    v_mov_b32 v235, 0
    v_mov_b32 v236, 0
    v_mov_b32 v237, 0
    v_mov_b32 v238, 0
    v_mov_b32 v239, 0
    s_waitcnt vmcnt(0)
    s_barrier
    ds_read_b64_tr_b16 v[96:97], v5 offset:0
    ds_read_b64_tr_b16 v[98:99], v5 offset:960
    ds_read_b64_tr_b16 v[100:101], v5 offset:7680
    ds_read_b64_tr_b16 v[102:103], v5 offset:8640
    ds_read_b64_tr_b16 v[104:105], v5 offset:32
    ds_read_b64_tr_b16 v[106:107], v5 offset:992
    ds_read_b64_tr_b16 v[108:109], v5 offset:7712
    ds_read_b64_tr_b16 v[110:111], v5 offset:8672
    ds_read_b64_tr_b16 v[112:113], v5 offset:64
    ds_read_b64_tr_b16 v[114:115], v5 offset:1024
    s_mov_b32 s46, 4
    s_lshr_b32 s47, s62, 2
    s_branch K3_ENTRY
K3_LOOP:
    s_waitcnt vmcnt(8)
    s_barrier
K3_ENTRY:
    s_cmp_eq_u32 s46, 1
    s_cselect_b32 s22, 0, 4194304
    s_waitcnt lgkmcnt(8)
    v_mfma_f32_16x16x32_bf16 v[128:131], v[96:99], v[64:67], v[128:131]
    ds_read_b64_tr_b16 v[116:117], v5 offset:7744
    v_mfma_f32_16x16x32_bf16 v[132:135], v[96:99], v[68:71], v[132:135]
    ds_read_b64_tr_b16 v[118:119], v5 offset:8704
    s_waitcnt lgkmcnt(8)
    v_mfma_f32_16x16x32_bf16 v[184:187], v[100:103], v[64:67], v[184:187]
    ds_read_b64_tr_b16 v[120:121], v5 offset:96
    v_mfma_f32_16x16x32_bf16 v[188:191], v[100:103], v[68:71], v[188:191]
    ds_read_b64_tr_b16 v[122:123], v5 offset:1056
    buffer_load_dwordx4 v[88:91], v4, s[16:19], s44 offen sc1
    s_waitcnt lgkmcnt(8)
    v_mfma_f32_16x16x32_bf16 v[136:139], v[104:107], v[64:67], v[136:139]
    ds_read_b64_tr_b16 v[96:97], v5 offset:7776
    v_mfma_f32_16x16x32_bf16 v[140:143], v[104:107], v[68:71], v[140:143]
    ds_read_b64_tr_b16 v[98:99], v5 offset:8736
    buffer_load_dwordx4 v[92:95], v4, s[16:19], s44 offen offset:1024 sc1
    s_add_u32 s44, s44, 2048
    s_waitcnt lgkmcnt(8)
    v_mfma_f32_16x16x32_bf16 v[192:195], v[108:111], v[64:67], v[192:195]
    ds_read_b64_tr_b16 v[100:101], v5 offset:128
    v_mfma_f32_16x16x32_bf16 v[196:199], v[108:111], v[68:71], v[196:199]
    ds_read_b64_tr_b16 v[102:103], v5 offset:1088
    s_waitcnt lgkmcnt(8)
    v_mfma_f32_16x16x32_bf16 v[144:147], v[112:115], v[64:67], v[144:147]
    ds_read_b64_tr_b16 v[104:105], v5 offset:7808
    v_mfma_f32_16x16x32_bf16 v[148:151], v[112:115], v[68:71], v[148:151]
    ds_read_b64_tr_b16 v[106:107], v5 offset:8768
    s_add_u32 m0, s58, 92160
    s_mov_b64 exec, s[40:41]
    buffer_load_dwordx4 v3, s[8:11], s45 offen lds
    s_mov_b64 exec, -1
    s_waitcnt lgkmcnt(8)
    v_mfma_f32_16x16x32_bf16 v[200:203], v[116:119], v[64:67], v[200:203]
    ds_read_b64_tr_b16 v[108:109], v5 offset:160
    v_mfma_f32_16x16x32_bf16 v[204:207], v[116:119], v[68:71], v[204:207]
    ds_read_b64_tr_b16 v[110:111], v5 offset:1120
    s_add_u32 m0, s58, 99840
    s_mov_b64 exec, s[40:41]
    buffer_load_dwordx4 v3, s[12:15], s45 offen lds
    s_mov_b64 exec, -1
    s_add_u32 s45, s45, 229376
    s_waitcnt lgkmcnt(8)
    v_mfma_f32_16x16x32_bf16 v[152:155], v[120:123], v[64:67], v[152:155]
    ds_read_b64_tr_b16 v[112:113], v5 offset:7840
    v_mfma_f32_16x16x32_bf16 v[156:159], v[120:123], v[68:71], v[156:159]
    ds_read_b64_tr_b16 v[114:115], v5 offset:8800
    s_waitcnt lgkmcnt(8)
    v_mfma_f32_16x16x32_bf16 v[208:211], v[96:99], v[64:67], v[208:211]
    ds_read_b64_tr_b16 v[116:117], v5 offset:192
    v_mfma_f32_16x16x32_bf16 v[212:215], v[96:99], v[68:71], v[212:215]
    ds_read_b64_tr_b16 v[118:119], v5 offset:1152
    s_waitcnt lgkmcnt(8)
    v_mfma_f32_16x16x32_bf16 v[160:163], v[100:103], v[64:67], v[160:163]
    ds_read_b64_tr_b16 v[120:121], v5 offset:7872
    v_mfma_f32_16x16x32_bf16 v[164:167], v[100:103], v[68:71], v[164:167]
    ds_read_b64_tr_b16 v[122:123], v5 offset:8832
    s_waitcnt lgkmcnt(8)
    v_mfma_f32_16x16x32_bf16 v[216:219], v[104:107], v[64:67], v[216:219]
    ds_read_b64_tr_b16 v[96:97], v5 offset:15360
    v_mfma_f32_16x16x32_bf16 v[220:223], v[104:107], v[68:71], v[220:223]
    ds_read_b64_tr_b16 v[98:99], v5 offset:16320
    s_waitcnt lgkmcnt(8)
    v_mfma_f32_16x16x32_bf16 v[168:171], v[108:111], v[64:67], v[168:171]
    ds_read_b64_tr_b16 v[100:101], v5 offset:23040
    v_mfma_f32_16x16x32_bf16 v[172:175], v[108:111], v[68:71], v[172:175]
    ds_read_b64_tr_b16 v[102:103], v5 offset:24000
    s_waitcnt lgkmcnt(8)
    v_mfma_f32_16x16x32_bf16 v[224:227], v[112:115], v[64:67], v[224:227]
    ds_read_b64_tr_b16 v[104:105], v5 offset:15392
    v_mfma_f32_16x16x32_bf16 v[228:231], v[112:115], v[68:71], v[228:231]
    ds_read_b64_tr_b16 v[106:107], v5 offset:16352
    s_waitcnt lgkmcnt(8)
    v_mfma_f32_16x16x32_bf16 v[176:179], v[116:119], v[64:67], v[176:179]
    ds_read_b64_tr_b16 v[108:109], v5 offset:23072
    v_mfma_f32_16x16x32_bf16 v[180:183], v[116:119], v[68:71], v[180:183]
    ds_read_b64_tr_b16 v[110:111], v5 offset:24032
    s_waitcnt lgkmcnt(8)
    v_mfma_f32_16x16x32_bf16 v[232:235], v[120:123], v[64:67], v[232:235]
    ds_read_b64_tr_b16 v[112:113], v5 offset:15424
    v_mfma_f32_16x16x32_bf16 v[236:239], v[120:123], v[68:71], v[236:239]
    ds_read_b64_tr_b16 v[114:115], v5 offset:16384
    s_waitcnt vmcnt(10)
    s_waitcnt lgkmcnt(8)
    v_mfma_f32_16x16x32_bf16 v[128:131], v[96:99], v[72:75], v[128:131]
    ds_read_b64_tr_b16 v[116:117], v5 offset:23104
    v_mfma_f32_16x16x32_bf16 v[132:135], v[96:99], v[76:79], v[132:135]
    ds_read_b64_tr_b16 v[118:119], v5 offset:24064
    s_waitcnt lgkmcnt(8)
    v_mfma_f32_16x16x32_bf16 v[184:187], v[100:103], v[72:75], v[184:187]
    ds_read_b64_tr_b16 v[120:121], v5 offset:15456
    v_mfma_f32_16x16x32_bf16 v[188:191], v[100:103], v[76:79], v[188:191]
    ds_read_b64_tr_b16 v[122:123], v5 offset:16416
    buffer_load_dwordx4 v[64:67], v4, s[16:19], s44 offen sc1
    s_waitcnt lgkmcnt(8)
    v_mfma_f32_16x16x32_bf16 v[136:139], v[104:107], v[72:75], v[136:139]
    ds_read_b64_tr_b16 v[96:97], v5 offset:23136
    v_mfma_f32_16x16x32_bf16 v[140:143], v[104:107], v[76:79], v[140:143]
    ds_read_b64_tr_b16 v[98:99], v5 offset:24096
    buffer_load_dwordx4 v[68:71], v4, s[16:19], s44 offen offset:1024 sc1
    s_add_u32 s44, s44, 2048
    s_waitcnt lgkmcnt(8)
    v_mfma_f32_16x16x32_bf16 v[192:195], v[108:111], v[72:75], v[192:195]
    ds_read_b64_tr_b16 v[100:101], v5 offset:15488
    v_mfma_f32_16x16x32_bf16 v[196:199], v[108:111], v[76:79], v[196:199]
    ds_read_b64_tr_b16 v[102:103], v5 offset:16448
    s_waitcnt lgkmcnt(8)
    v_mfma_f32_16x16x32_bf16 v[144:147], v[112:115], v[72:75], v[144:147]
    ds_read_b64_tr_b16 v[104:105], v5 offset:23168
    v_mfma_f32_16x16x32_bf16 v[148:151], v[112:115], v[76:79], v[148:151]
    ds_read_b64_tr_b16 v[106:107], v5 offset:24128
    s_add_u32 m0, s58, 107520
    s_mov_b64 exec, s[40:41]
    buffer_load_dwordx4 v3, s[8:11], s45 offen lds
    s_mov_b64 exec, -1
    s_waitcnt lgkmcnt(8)
    v_mfma_f32_16x16x32_bf16 v[200:203], v[116:119], v[72:75], v[200:203]
    ds_read_b64_tr_b16 v[108:109], v5 offset:15520
    v_mfma_f32_16x16x32_bf16 v[204:207], v[116:119], v[76:79], v[204:207]
    ds_read_b64_tr_b16 v[110:111], v5 offset:16480
    s_add_u32 m0, s58, 115200
    s_mov_b64 exec, s[40:41]
    buffer_load_dwordx4 v3, s[12:15], s45 offen lds
    s_mov_b64 exec, -1
    s_add_u32 s45, s45, 229376
    s_waitcnt lgkmcnt(8)
    v_mfma_f32_16x16x32_bf16 v[152:155], v[120:123], v[72:75], v[152:155]
    ds_read_b64_tr_b16 v[112:113], v5 offset:23200
    v_mfma_f32_16x16x32_bf16 v[156:159], v[120:123], v[76:79], v[156:159]
    ds_read_b64_tr_b16 v[114:115], v5 offset:24160
    s_waitcnt lgkmcnt(8)
    v_mfma_f32_16x16x32_bf16 v[208:211], v[96:99], v[72:75], v[208:211]
    ds_read_b64_tr_b16 v[116:117], v5 offset:15552
    v_mfma_f32_16x16x32_bf16 v[212:215], v[96:99], v[76:79], v[212:215]
    ds_read_b64_tr_b16 v[118:119], v5 offset:16512
    s_waitcnt lgkmcnt(8)
    v_mfma_f32_16x16x32_bf16 v[160:163], v[100:103], v[72:75], v[160:163]
    ds_read_b64_tr_b16 v[120:121], v5 offset:23232
    v_mfma_f32_16x16x32_bf16 v[164:167], v[100:103], v[76:79], v[164:167]
    ds_read_b64_tr_b16 v[122:123], v5 offset:24192
    s_waitcnt lgkmcnt(8)
    v_mfma_f32_16x16x32_bf16 v[216:219], v[104:107], v[72:75], v[216:219]
    ds_read_b64_tr_b16 v[96:97], v5 offset:30720
    v_mfma_f32_16x16x32_bf16 v[220:223], v[104:107], v[76:79], v[220:223]
    ds_read_b64_tr_b16 v[98:99], v5 offset:31680
    s_waitcnt lgkmcnt(8)
    v_mfma_f32_16x16x32_bf16 v[168:171], v[108:111], v[72:75], v[168:171]
    ds_read_b64_tr_b16 v[100:101], v5 offset:38400
    v_mfma_f32_16x16x32_bf16 v[172:175], v[108:111], v[76:79], v[172:175]
    ds_read_b64_tr_b16 v[102:103], v5 offset:39360
    s_waitcnt lgkmcnt(8)
    v_mfma_f32_16x16x32_bf16 v[224:227], v[112:115], v[72:75], v[224:227]
    ds_read_b64_tr_b16 v[104:105], v5 offset:30752
    v_mfma_f32_16x16x32_bf16 v[228:231], v[112:115], v[76:79], v[228:231]
    ds_read_b64_tr_b16 v[106:107], v5 offset:31712
    s_waitcnt lgkmcnt(8)
    v_mfma_f32_16x16x32_bf16 v[176:179], v[116:119], v[72:75], v[176:179]
    ds_read_b64_tr_b16 v[108:109], v5 offset:38432
    v_mfma_f32_16x16x32_bf16 v[180:183], v[116:119], v[76:79], v[180:183]
    ds_read_b64_tr_b16 v[110:111], v5 offset:39392
    s_waitcnt lgkmcnt(8)
    v_mfma_f32_16x16x32_bf16 v[232:235], v[120:123], v[72:75], v[232:235]
    ds_read_b64_tr_b16 v[112:113], v5 offset:30784
    v_mfma_f32_16x16x32_bf16 v[236:239], v[120:123], v[76:79], v[236:239]
    ds_read_b64_tr_b16 v[114:115], v5 offset:31744
    s_waitcnt vmcnt(8)
    s_barrier
    s_waitcnt lgkmcnt(8)
    v_mfma_f32_16x16x32_bf16 v[128:131], v[96:99], v[80:83], v[128:131]
    ds_read_b64_tr_b16 v[116:117], v5 offset:38464
    v_mfma_f32_16x16x32_bf16 v[132:135], v[96:99], v[84:87], v[132:135]
    ds_read_b64_tr_b16 v[118:119], v5 offset:39424
    s_waitcnt lgkmcnt(8)
    v_mfma_f32_16x16x32_bf16 v[184:187], v[100:103], v[80:83], v[184:187]
    ds_read_b64_tr_b16 v[120:121], v5 offset:30816
    v_mfma_f32_16x16x32_bf16 v[188:191], v[100:103], v[84:87], v[188:191]
    ds_read_b64_tr_b16 v[122:123], v5 offset:31776
    buffer_load_dwordx4 v[72:75], v4, s[16:19], s44 offen sc1
    s_waitcnt lgkmcnt(8)
    v_mfma_f32_16x16x32_bf16 v[136:139], v[104:107], v[80:83], v[136:139]
    ds_read_b64_tr_b16 v[96:97], v5 offset:38496
    v_mfma_f32_16x16x32_bf16 v[140:143], v[104:107], v[84:87], v[140:143]
    ds_read_b64_tr_b16 v[98:99], v5 offset:39456
    buffer_load_dwordx4 v[76:79], v4, s[16:19], s44 offen offset:1024 sc1
    s_add_u32 s44, s44, 2048
    s_waitcnt lgkmcnt(8)
    v_mfma_f32_16x16x32_bf16 v[192:195], v[108:111], v[80:83], v[192:195]
    ds_read_b64_tr_b16 v[100:101], v5 offset:30848
    v_mfma_f32_16x16x32_bf16 v[196:199], v[108:111], v[84:87], v[196:199]
    ds_read_b64_tr_b16 v[102:103], v5 offset:31808
    s_waitcnt lgkmcnt(8)
    v_mfma_f32_16x16x32_bf16 v[144:147], v[112:115], v[80:83], v[144:147]
    ds_read_b64_tr_b16 v[104:105], v5 offset:38528
    v_mfma_f32_16x16x32_bf16 v[148:151], v[112:115], v[84:87], v[148:151]
    ds_read_b64_tr_b16 v[106:107], v5 offset:39488
    s_add_u32 m0, s58, 0
    s_mov_b64 exec, s[40:41]
    buffer_load_dwordx4 v3, s[8:11], s45 offen lds
    s_mov_b64 exec, -1
    s_waitcnt lgkmcnt(8)
    v_mfma_f32_16x16x32_bf16 v[200:203], v[116:119], v[80:83], v[200:203]
    ds_read_b64_tr_b16 v[108:109], v5 offset:30880
    v_mfma_f32_16x16x32_bf16 v[204:207], v[116:119], v[84:87], v[204:207]
    ds_read_b64_tr_b16 v[110:111], v5 offset:31840
    s_add_u32 m0, s58, 7680
    s_mov_b64 exec, s[40:41]
    buffer_load_dwordx4 v3, s[12:15], s45 offen lds
    s_mov_b64 exec, -1
    s_add_u32 s45, s45, 229376
    s_waitcnt lgkmcnt(8)
    v_mfma_f32_16x16x32_bf16 v[152:155], v[120:123], v[80:83], v[152:155]
    ds_read_b64_tr_b16 v[112:113], v5 offset:38560
    v_mfma_f32_16x16x32_bf16 v[156:159], v[120:123], v[84:87], v[156:159]
    ds_read_b64_tr_b16 v[114:115], v5 offset:39520
    s_waitcnt lgkmcnt(8)
    v_mfma_f32_16x16x32_bf16 v[208:211], v[96:99], v[80:83], v[208:211]
    ds_read_b64_tr_b16 v[116:117], v5 offset:30912
    v_mfma_f32_16x16x32_bf16 v[212:215], v[96:99], v[84:87], v[212:215]
    ds_read_b64_tr_b16 v[118:119], v5 offset:31872
    s_waitcnt lgkmcnt(8)
    v_mfma_f32_16x16x32_bf16 v[160:163], v[100:103], v[80:83], v[160:163]
    ds_read_b64_tr_b16 v[120:121], v5 offset:38592
    v_mfma_f32_16x16x32_bf16 v[164:167], v[100:103], v[84:87], v[164:167]
    ds_read_b64_tr_b16 v[122:123], v5 offset:39552
    s_waitcnt lgkmcnt(8)
    v_mfma_f32_16x16x32_bf16 v[216:219], v[104:107], v[80:83], v[216:219]
    ds_read_b64_tr_b16 v[96:97], v5 offset:46080
    v_mfma_f32_16x16x32_bf16 v[220:223], v[104:107], v[84:87], v[220:223]
    ds_read_b64_tr_b16 v[98:99], v5 offset:47040
    s_waitcnt lgkmcnt(8)
    v_mfma_f32_16x16x32_bf16 v[168:171], v[108:111], v[80:83], v[168:171]
    ds_read_b64_tr_b16 v[100:101], v5 offset:53760
    v_mfma_f32_16x16x32_bf16 v[172:175], v[108:111], v[84:87], v[172:175]
    ds_read_b64_tr_b16 v[102:103], v5 offset:54720
    s_waitcnt lgkmcnt(8)
    v_mfma_f32_16x16x32_bf16 v[224:227], v[112:115], v[80:83], v[224:227]
    ds_read_b64_tr_b16 v[104:105], v5 offset:46112
    v_mfma_f32_16x16x32_bf16 v[228:231], v[112:115], v[84:87], v[228:231]
    ds_read_b64_tr_b16 v[106:107], v5 offset:47072
    s_waitcnt lgkmcnt(8)
    v_mfma_f32_16x16x32_bf16 v[176:179], v[116:119], v[80:83], v[176:179]
    ds_read_b64_tr_b16 v[108:109], v5 offset:53792
    v_mfma_f32_16x16x32_bf16 v[180:183], v[116:119], v[84:87], v[180:183]
    ds_read_b64_tr_b16 v[110:111], v5 offset:54752
    s_waitcnt lgkmcnt(8)
    v_mfma_f32_16x16x32_bf16 v[232:235], v[120:123], v[80:83], v[232:235]
    ds_read_b64_tr_b16 v[112:113], v5 offset:46144
    v_mfma_f32_16x16x32_bf16 v[236:239], v[120:123], v[84:87], v[236:239]
    ds_read_b64_tr_b16 v[114:115], v5 offset:47104
    s_waitcnt vmcnt(10)
    s_waitcnt lgkmcnt(8)
    v_mfma_f32_16x16x32_bf16 v[128:131], v[96:99], v[88:91], v[128:131]
    ds_read_b64_tr_b16 v[116:117], v5 offset:53824
    v_mfma_f32_16x16x32_bf16 v[132:135], v[96:99], v[92:95], v[132:135]
    ds_read_b64_tr_b16 v[118:119], v5 offset:54784
    s_waitcnt lgkmcnt(8)
    v_mfma_f32_16x16x32_bf16 v[184:187], v[100:103], v[88:91], v[184:187]
    ds_read_b64_tr_b16 v[120:121], v5 offset:46176
    v_mfma_f32_16x16x32_bf16 v[188:191], v[100:103], v[92:95], v[188:191]
    ds_read_b64_tr_b16 v[122:123], v5 offset:47136
    buffer_load_dwordx4 v[80:83], v4, s[16:19], s44 offen sc1
    s_waitcnt lgkmcnt(8)
    v_mfma_f32_16x16x32_bf16 v[136:139], v[104:107], v[88:91], v[136:139]
    ds_read_b64_tr_b16 v[96:97], v5 offset:53856
    v_mfma_f32_16x16x32_bf16 v[140:143], v[104:107], v[92:95], v[140:143]
    ds_read_b64_tr_b16 v[98:99], v5 offset:54816
    buffer_load_dwordx4 v[84:87], v4, s[16:19], s44 offen offset:1024 sc1
    s_add_u32 s44, s44, 2048
    s_waitcnt lgkmcnt(8)
    v_mfma_f32_16x16x32_bf16 v[192:195], v[108:111], v[88:91], v[192:195]
    ds_read_b64_tr_b16 v[100:101], v5 offset:46208
    v_mfma_f32_16x16x32_bf16 v[196:199], v[108:111], v[92:95], v[196:199]
    ds_read_b64_tr_b16 v[102:103], v5 offset:47168
    s_waitcnt lgkmcnt(8)
    v_mfma_f32_16x16x32_bf16 v[144:147], v[112:115], v[88:91], v[144:147]
    ds_read_b64_tr_b16 v[104:105], v5 offset:53888
    v_mfma_f32_16x16x32_bf16 v[148:151], v[112:115], v[92:95], v[148:151]
    ds_read_b64_tr_b16 v[106:107], v5 offset:54848
    s_add_u32 m0, s58, 15360
    s_mov_b64 exec, s[40:41]
    buffer_load_dwordx4 v3, s[8:11], s45 offen lds
    s_mov_b64 exec, -1
    s_waitcnt lgkmcnt(8)
    v_mfma_f32_16x16x32_bf16 v[200:203], v[116:119], v[88:91], v[200:203]
    ds_read_b64_tr_b16 v[108:109], v5 offset:46240
    v_mfma_f32_16x16x32_bf16 v[204:207], v[116:119], v[92:95], v[204:207]
    ds_read_b64_tr_b16 v[110:111], v5 offset:47200
    s_add_u32 m0, s58, 23040
    s_mov_b64 exec, s[40:41]
    buffer_load_dwordx4 v3, s[12:15], s45 offen lds
    s_mov_b64 exec, -1
    s_add_u32 s45, s45, 229376
    s_waitcnt lgkmcnt(8)
    v_mfma_f32_16x16x32_bf16 v[152:155], v[120:123], v[88:91], v[152:155]
    ds_read_b64_tr_b16 v[112:113], v5 offset:53920
    v_mfma_f32_16x16x32_bf16 v[156:159], v[120:123], v[92:95], v[156:159]
    ds_read_b64_tr_b16 v[114:115], v5 offset:54880
    s_waitcnt lgkmcnt(8)
    v_mfma_f32_16x16x32_bf16 v[208:211], v[96:99], v[88:91], v[208:211]
    ds_read_b64_tr_b16 v[116:117], v5 offset:46272
    v_mfma_f32_16x16x32_bf16 v[212:215], v[96:99], v[92:95], v[212:215]
    ds_read_b64_tr_b16 v[118:119], v5 offset:47232
    s_waitcnt lgkmcnt(8)
    v_mfma_f32_16x16x32_bf16 v[160:163], v[100:103], v[88:91], v[160:163]
    ds_read_b64_tr_b16 v[120:121], v5 offset:53952
    v_mfma_f32_16x16x32_bf16 v[164:167], v[100:103], v[92:95], v[164:167]
    ds_read_b64_tr_b16 v[122:123], v5 offset:54912
    s_waitcnt lgkmcnt(8)
    v_mfma_f32_16x16x32_bf16 v[216:219], v[104:107], v[88:91], v[216:219]
    ds_read_b64_tr_b16 v[96:97], v6 offset:0
    v_mfma_f32_16x16x32_bf16 v[220:223], v[104:107], v[92:95], v[220:223]
    ds_read_b64_tr_b16 v[98:99], v6 offset:960
    s_waitcnt lgkmcnt(8)
    v_mfma_f32_16x16x32_bf16 v[168:171], v[108:111], v[88:91], v[168:171]
    ds_read_b64_tr_b16 v[100:101], v6 offset:7680
    v_mfma_f32_16x16x32_bf16 v[172:175], v[108:111], v[92:95], v[172:175]
    ds_read_b64_tr_b16 v[102:103], v6 offset:8640
    s_waitcnt lgkmcnt(8)
    v_mfma_f32_16x16x32_bf16 v[224:227], v[112:115], v[88:91], v[224:227]
    ds_read_b64_tr_b16 v[104:105], v6 offset:32
    v_mfma_f32_16x16x32_bf16 v[228:231], v[112:115], v[92:95], v[228:231]
    ds_read_b64_tr_b16 v[106:107], v6 offset:992
    s_waitcnt lgkmcnt(8)
    v_mfma_f32_16x16x32_bf16 v[176:179], v[116:119], v[88:91], v[176:179]
    ds_read_b64_tr_b16 v[108:109], v6 offset:7712
    v_mfma_f32_16x16x32_bf16 v[180:183], v[116:119], v[92:95], v[180:183]
    ds_read_b64_tr_b16 v[110:111], v6 offset:8672
    s_waitcnt lgkmcnt(8)
    v_mfma_f32_16x16x32_bf16 v[232:235], v[120:123], v[88:91], v[232:235]
    ds_read_b64_tr_b16 v[112:113], v6 offset:64
    v_mfma_f32_16x16x32_bf16 v[236:239], v[120:123], v[92:95], v[236:239]
    ds_read_b64_tr_b16 v[114:115], v6 offset:1024
    s_waitcnt vmcnt(8)
    s_barrier
    s_waitcnt lgkmcnt(8)
    v_mfma_f32_16x16x32_bf16 v[128:131], v[96:99], v[64:67], v[128:131]
    ds_read_b64_tr_b16 v[116:117], v6 offset:7744
    v_mfma_f32_16x16x32_bf16 v[132:135], v[96:99], v[68:71], v[132:135]
    ds_read_b64_tr_b16 v[118:119], v6 offset:8704
    s_waitcnt lgkmcnt(8)
    v_mfma_f32_16x16x32_bf16 v[184:187], v[100:103], v[64:67], v[184:187]
    ds_read_b64_tr_b16 v[120:121], v6 offset:96
    v_mfma_f32_16x16x32_bf16 v[188:191], v[100:103], v[68:71], v[188:191]
    ds_read_b64_tr_b16 v[122:123], v6 offset:1056
    buffer_load_dwordx4 v[88:91], v4, s[16:19], s44 offen sc1
    s_waitcnt lgkmcnt(8)
    v_mfma_f32_16x16x32_bf16 v[136:139], v[104:107], v[64:67], v[136:139]
    ds_read_b64_tr_b16 v[96:97], v6 offset:7776
    v_mfma_f32_16x16x32_bf16 v[140:143], v[104:107], v[68:71], v[140:143]
    ds_read_b64_tr_b16 v[98:99], v6 offset:8736
    buffer_load_dwordx4 v[92:95], v4, s[16:19], s44 offen offset:1024 sc1
    s_add_u32 s44, s44, 2048
    s_waitcnt lgkmcnt(8)
    v_mfma_f32_16x16x32_bf16 v[192:195], v[108:111], v[64:67], v[192:195]
    ds_read_b64_tr_b16 v[100:101], v6 offset:128
    v_mfma_f32_16x16x32_bf16 v[196:199], v[108:111], v[68:71], v[196:199]
    ds_read_b64_tr_b16 v[102:103], v6 offset:1088
    s_waitcnt lgkmcnt(8)
    v_mfma_f32_16x16x32_bf16 v[144:147], v[112:115], v[64:67], v[144:147]
    ds_read_b64_tr_b16 v[104:105], v6 offset:7808
    v_mfma_f32_16x16x32_bf16 v[148:151], v[112:115], v[68:71], v[148:151]
    ds_read_b64_tr_b16 v[106:107], v6 offset:8768
    s_add_u32 m0, s58, 30720
    s_mov_b64 exec, s[40:41]
    buffer_load_dwordx4 v3, s[8:11], s45 offen lds
    s_mov_b64 exec, -1
    s_waitcnt lgkmcnt(8)
    v_mfma_f32_16x16x32_bf16 v[200:203], v[116:119], v[64:67], v[200:203]
    ds_read_b64_tr_b16 v[108:109], v6 offset:160
    v_mfma_f32_16x16x32_bf16 v[204:207], v[116:119], v[68:71], v[204:207]
    ds_read_b64_tr_b16 v[110:111], v6 offset:1120
    s_add_u32 m0, s58, 38400
    s_mov_b64 exec, s[40:41]
    buffer_load_dwordx4 v3, s[12:15], s45 offen lds
    s_mov_b64 exec, -1
    s_add_u32 s45, s45, 229376
    s_waitcnt lgkmcnt(8)
    v_mfma_f32_16x16x32_bf16 v[152:155], v[120:123], v[64:67], v[152:155]
    ds_read_b64_tr_b16 v[112:113], v6 offset:7840
    v_mfma_f32_16x16x32_bf16 v[156:159], v[120:123], v[68:71], v[156:159]
    ds_read_b64_tr_b16 v[114:115], v6 offset:8800
    s_waitcnt lgkmcnt(8)
    v_mfma_f32_16x16x32_bf16 v[208:211], v[96:99], v[64:67], v[208:211]
    ds_read_b64_tr_b16 v[116:117], v6 offset:192
    v_mfma_f32_16x16x32_bf16 v[212:215], v[96:99], v[68:71], v[212:215]
    ds_read_b64_tr_b16 v[118:119], v6 offset:1152
    s_waitcnt lgkmcnt(8)
    v_mfma_f32_16x16x32_bf16 v[160:163], v[100:103], v[64:67], v[160:163]
    ds_read_b64_tr_b16 v[120:121], v6 offset:7872
    v_mfma_f32_16x16x32_bf16 v[164:167], v[100:103], v[68:71], v[164:167]
    ds_read_b64_tr_b16 v[122:123], v6 offset:8832
    s_waitcnt lgkmcnt(8)
    v_mfma_f32_16x16x32_bf16 v[216:219], v[104:107], v[64:67], v[216:219]
    ds_read_b64_tr_b16 v[96:97], v6 offset:15360
    v_mfma_f32_16x16x32_bf16 v[220:223], v[104:107], v[68:71], v[220:223]
    ds_read_b64_tr_b16 v[98:99], v6 offset:16320
    s_waitcnt lgkmcnt(8)
    v_mfma_f32_16x16x32_bf16 v[168:171], v[108:111], v[64:67], v[168:171]
    ds_read_b64_tr_b16 v[100:101], v6 offset:23040
    v_mfma_f32_16x16x32_bf16 v[172:175], v[108:111], v[68:71], v[172:175]
    ds_read_b64_tr_b16 v[102:103], v6 offset:24000
    s_waitcnt lgkmcnt(8)
    v_mfma_f32_16x16x32_bf16 v[224:227], v[112:115], v[64:67], v[224:227]
    ds_read_b64_tr_b16 v[104:105], v6 offset:15392
    v_mfma_f32_16x16x32_bf16 v[228:231], v[112:115], v[68:71], v[228:231]
    ds_read_b64_tr_b16 v[106:107], v6 offset:16352
    s_waitcnt lgkmcnt(8)
    v_mfma_f32_16x16x32_bf16 v[176:179], v[116:119], v[64:67], v[176:179]
    ds_read_b64_tr_b16 v[108:109], v6 offset:23072
    v_mfma_f32_16x16x32_bf16 v[180:183], v[116:119], v[68:71], v[180:183]
    ds_read_b64_tr_b16 v[110:111], v6 offset:24032
    s_waitcnt lgkmcnt(8)
    v_mfma_f32_16x16x32_bf16 v[232:235], v[120:123], v[64:67], v[232:235]
    ds_read_b64_tr_b16 v[112:113], v6 offset:15424
    v_mfma_f32_16x16x32_bf16 v[236:239], v[120:123], v[68:71], v[236:239]
    ds_read_b64_tr_b16 v[114:115], v6 offset:16384
    s_waitcnt vmcnt(10)
    s_waitcnt lgkmcnt(8)
    v_mfma_f32_16x16x32_bf16 v[128:131], v[96:99], v[72:75], v[128:131]
    ds_read_b64_tr_b16 v[116:117], v6 offset:23104
    v_mfma_f32_16x16x32_bf16 v[132:135], v[96:99], v[76:79], v[132:135]
    ds_read_b64_tr_b16 v[118:119], v6 offset:24064
    s_waitcnt lgkmcnt(8)
    v_mfma_f32_16x16x32_bf16 v[184:187], v[100:103], v[72:75], v[184:187]
    ds_read_b64_tr_b16 v[120:121], v6 offset:15456
    v_mfma_f32_16x16x32_bf16 v[188:191], v[100:103], v[76:79], v[188:191]
    ds_read_b64_tr_b16 v[122:123], v6 offset:16416
    buffer_load_dwordx4 v[64:67], v4, s[20:23], s44 offen sc1
    s_waitcnt lgkmcnt(8)
    v_mfma_f32_16x16x32_bf16 v[136:139], v[104:107], v[72:75], v[136:139]
    ds_read_b64_tr_b16 v[96:97], v6 offset:23136
    v_mfma_f32_16x16x32_bf16 v[140:143], v[104:107], v[76:79], v[140:143]
    ds_read_b64_tr_b16 v[98:99], v6 offset:24096
    buffer_load_dwordx4 v[68:71], v4, s[20:23], s44 offen offset:1024 sc1
    s_add_u32 s44, s44, 2048
    s_waitcnt lgkmcnt(8)
    v_mfma_f32_16x16x32_bf16 v[192:195], v[108:111], v[72:75], v[192:195]
    ds_read_b64_tr_b16 v[100:101], v6 offset:15488
    v_mfma_f32_16x16x32_bf16 v[196:199], v[108:111], v[76:79], v[196:199]
    ds_read_b64_tr_b16 v[102:103], v6 offset:16448
    s_waitcnt lgkmcnt(8)
    v_mfma_f32_16x16x32_bf16 v[144:147], v[112:115], v[72:75], v[144:147]
    ds_read_b64_tr_b16 v[104:105], v6 offset:23168
    v_mfma_f32_16x16x32_bf16 v[148:151], v[112:115], v[76:79], v[148:151]
    ds_read_b64_tr_b16 v[106:107], v6 offset:24128
    s_add_u32 m0, s58, 46080
    s_mov_b64 exec, s[40:41]
    buffer_load_dwordx4 v3, s[8:11], s45 offen lds
    s_mov_b64 exec, -1
    s_waitcnt lgkmcnt(8)
    v_mfma_f32_16x16x32_bf16 v[200:203], v[116:119], v[72:75], v[200:203]
    ds_read_b64_tr_b16 v[108:109], v6 offset:15520
    v_mfma_f32_16x16x32_bf16 v[204:207], v[116:119], v[76:79], v[204:207]
    ds_read_b64_tr_b16 v[110:111], v6 offset:16480
    s_add_u32 m0, s58, 53760
    s_mov_b64 exec, s[40:41]
    buffer_load_dwordx4 v3, s[12:15], s45 offen lds
    s_mov_b64 exec, -1
    s_add_u32 s45, s45, 229376
    s_waitcnt lgkmcnt(8)
    v_mfma_f32_16x16x32_bf16 v[152:155], v[120:123], v[72:75], v[152:155]
    ds_read_b64_tr_b16 v[112:113], v6 offset:23200
    v_mfma_f32_16x16x32_bf16 v[156:159], v[120:123], v[76:79], v[156:159]
    ds_read_b64_tr_b16 v[114:115], v6 offset:24160
    s_waitcnt lgkmcnt(8)
    v_mfma_f32_16x16x32_bf16 v[208:211], v[96:99], v[72:75], v[208:211]
    ds_read_b64_tr_b16 v[116:117], v6 offset:15552
    v_mfma_f32_16x16x32_bf16 v[212:215], v[96:99], v[76:79], v[212:215]
    ds_read_b64_tr_b16 v[118:119], v6 offset:16512
    s_waitcnt lgkmcnt(8)
    v_mfma_f32_16x16x32_bf16 v[160:163], v[100:103], v[72:75], v[160:163]
    ds_read_b64_tr_b16 v[120:121], v6 offset:23232
    v_mfma_f32_16x16x32_bf16 v[164:167], v[100:103], v[76:79], v[164:167]
    ds_read_b64_tr_b16 v[122:123], v6 offset:24192
    s_waitcnt lgkmcnt(8)
    v_mfma_f32_16x16x32_bf16 v[216:219], v[104:107], v[72:75], v[216:219]
    ds_read_b64_tr_b16 v[96:97], v6 offset:30720
    v_mfma_f32_16x16x32_bf16 v[220:223], v[104:107], v[76:79], v[220:223]
    ds_read_b64_tr_b16 v[98:99], v6 offset:31680
    s_waitcnt lgkmcnt(8)
    v_mfma_f32_16x16x32_bf16 v[168:171], v[108:111], v[72:75], v[168:171]
    ds_read_b64_tr_b16 v[100:101], v6 offset:38400
    v_mfma_f32_16x16x32_bf16 v[172:175], v[108:111], v[76:79], v[172:175]
    ds_read_b64_tr_b16 v[102:103], v6 offset:39360
    s_waitcnt lgkmcnt(8)
    v_mfma_f32_16x16x32_bf16 v[224:227], v[112:115], v[72:75], v[224:227]
    ds_read_b64_tr_b16 v[104:105], v6 offset:30752
    v_mfma_f32_16x16x32_bf16 v[228:231], v[112:115], v[76:79], v[228:231]
    ds_read_b64_tr_b16 v[106:107], v6 offset:31712
    s_waitcnt lgkmcnt(8)
    v_mfma_f32_16x16x32_bf16 v[176:179], v[116:119], v[72:75], v[176:179]
    ds_read_b64_tr_b16 v[108:109], v6 offset:38432
    v_mfma_f32_16x16x32_bf16 v[180:183], v[116:119], v[76:79], v[180:183]
    ds_read_b64_tr_b16 v[110:111], v6 offset:39392
    s_waitcnt lgkmcnt(8)
    v_mfma_f32_16x16x32_bf16 v[232:235], v[120:123], v[72:75], v[232:235]
    ds_read_b64_tr_b16 v[112:113], v6 offset:30784
    v_mfma_f32_16x16x32_bf16 v[236:239], v[120:123], v[76:79], v[236:239]
    ds_read_b64_tr_b16 v[114:115], v6 offset:31744
    s_waitcnt vmcnt(8)
    s_barrier
    s_waitcnt lgkmcnt(8)
    v_mfma_f32_16x16x32_bf16 v[128:131], v[96:99], v[80:83], v[128:131]
    ds_read_b64_tr_b16 v[116:117], v6 offset:38464
    v_mfma_f32_16x16x32_bf16 v[132:135], v[96:99], v[84:87], v[132:135]
    ds_read_b64_tr_b16 v[118:119], v6 offset:39424
    s_waitcnt lgkmcnt(8)
    v_mfma_f32_16x16x32_bf16 v[184:187], v[100:103], v[80:83], v[184:187]
    ds_read_b64_tr_b16 v[120:121], v6 offset:30816
    v_mfma_f32_16x16x32_bf16 v[188:191], v[100:103], v[84:87], v[188:191]
    ds_read_b64_tr_b16 v[122:123], v6 offset:31776
    buffer_load_dwordx4 v[72:75], v4, s[20:23], s44 offen sc1
    s_waitcnt lgkmcnt(8)
    v_mfma_f32_16x16x32_bf16 v[136:139], v[104:107], v[80:83], v[136:139]
    ds_read_b64_tr_b16 v[96:97], v6 offset:38496
    v_mfma_f32_16x16x32_bf16 v[140:143], v[104:107], v[84:87], v[140:143]
    ds_read_b64_tr_b16 v[98:99], v6 offset:39456
    buffer_load_dwordx4 v[76:79], v4, s[20:23], s44 offen offset:1024 sc1
    s_add_u32 s44, s44, 2048
    s_waitcnt lgkmcnt(8)
    v_mfma_f32_16x16x32_bf16 v[192:195], v[108:111], v[80:83], v[192:195]
    ds_read_b64_tr_b16 v[100:101], v6 offset:30848
    v_mfma_f32_16x16x32_bf16 v[196:199], v[108:111], v[84:87], v[196:199]
    ds_read_b64_tr_b16 v[102:103], v6 offset:31808
    s_waitcnt lgkmcnt(8)
    v_mfma_f32_16x16x32_bf16 v[144:147], v[112:115], v[80:83], v[144:147]
    ds_read_b64_tr_b16 v[104:105], v6 offset:38528
    v_mfma_f32_16x16x32_bf16 v[148:151], v[112:115], v[84:87], v[148:151]
    ds_read_b64_tr_b16 v[106:107], v6 offset:39488
    s_add_u32 m0, s58, 61440
    s_mov_b64 exec, s[40:41]
    buffer_load_dwordx4 v3, s[8:11], s45 offen lds
    s_mov_b64 exec, -1
    s_waitcnt lgkmcnt(8)
    v_mfma_f32_16x16x32_bf16 v[200:203], v[116:119], v[80:83], v[200:203]
    ds_read_b64_tr_b16 v[108:109], v6 offset:30880
    v_mfma_f32_16x16x32_bf16 v[204:207], v[116:119], v[84:87], v[204:207]
    ds_read_b64_tr_b16 v[110:111], v6 offset:31840
    s_add_u32 m0, s58, 69120
    s_mov_b64 exec, s[40:41]
    buffer_load_dwordx4 v3, s[12:15], s45 offen lds
    s_mov_b64 exec, -1
    s_add_u32 s45, s45, 229376
    s_waitcnt lgkmcnt(8)
    v_mfma_f32_16x16x32_bf16 v[152:155], v[120:123], v[80:83], v[152:155]
    ds_read_b64_tr_b16 v[112:113], v6 offset:38560
    v_mfma_f32_16x16x32_bf16 v[156:159], v[120:123], v[84:87], v[156:159]
    ds_read_b64_tr_b16 v[114:115], v6 offset:39520
    s_waitcnt lgkmcnt(8)
    v_mfma_f32_16x16x32_bf16 v[208:211], v[96:99], v[80:83], v[208:211]
    ds_read_b64_tr_b16 v[116:117], v6 offset:30912
    v_mfma_f32_16x16x32_bf16 v[212:215], v[96:99], v[84:87], v[212:215]
    ds_read_b64_tr_b16 v[118:119], v6 offset:31872
    s_waitcnt lgkmcnt(8)
    v_mfma_f32_16x16x32_bf16 v[160:163], v[100:103], v[80:83], v[160:163]
    ds_read_b64_tr_b16 v[120:121], v6 offset:38592
    v_mfma_f32_16x16x32_bf16 v[164:167], v[100:103], v[84:87], v[164:167]
    ds_read_b64_tr_b16 v[122:123], v6 offset:39552
    s_waitcnt lgkmcnt(8)
    v_mfma_f32_16x16x32_bf16 v[216:219], v[104:107], v[80:83], v[216:219]
    ds_read_b64_tr_b16 v[96:97], v6 offset:46080
    v_mfma_f32_16x16x32_bf16 v[220:223], v[104:107], v[84:87], v[220:223]
    ds_read_b64_tr_b16 v[98:99], v6 offset:47040
    s_waitcnt lgkmcnt(8)
    v_mfma_f32_16x16x32_bf16 v[168:171], v[108:111], v[80:83], v[168:171]
    ds_read_b64_tr_b16 v[100:101], v6 offset:53760
    v_mfma_f32_16x16x32_bf16 v[172:175], v[108:111], v[84:87], v[172:175]
    ds_read_b64_tr_b16 v[102:103], v6 offset:54720
    s_waitcnt lgkmcnt(8)
    v_mfma_f32_16x16x32_bf16 v[224:227], v[112:115], v[80:83], v[224:227]
    ds_read_b64_tr_b16 v[104:105], v6 offset:46112
    v_mfma_f32_16x16x32_bf16 v[228:231], v[112:115], v[84:87], v[228:231]
    ds_read_b64_tr_b16 v[106:107], v6 offset:47072
    s_waitcnt lgkmcnt(8)
    v_mfma_f32_16x16x32_bf16 v[176:179], v[116:119], v[80:83], v[176:179]
    ds_read_b64_tr_b16 v[108:109], v6 offset:53792
    v_mfma_f32_16x16x32_bf16 v[180:183], v[116:119], v[84:87], v[180:183]
    ds_read_b64_tr_b16 v[110:111], v6 offset:54752
    s_waitcnt lgkmcnt(8)
    v_mfma_f32_16x16x32_bf16 v[232:235], v[120:123], v[80:83], v[232:235]
    ds_read_b64_tr_b16 v[112:113], v6 offset:46144
    v_mfma_f32_16x16x32_bf16 v[236:239], v[120:123], v[84:87], v[236:239]
    ds_read_b64_tr_b16 v[114:115], v6 offset:47104
    s_waitcnt vmcnt(10)
    s_waitcnt lgkmcnt(8)
    v_mfma_f32_16x16x32_bf16 v[128:131], v[96:99], v[88:91], v[128:131]
    ds_read_b64_tr_b16 v[116:117], v6 offset:53824
    v_mfma_f32_16x16x32_bf16 v[132:135], v[96:99], v[92:95], v[132:135]
    ds_read_b64_tr_b16 v[118:119], v6 offset:54784
    s_waitcnt lgkmcnt(8)
    v_mfma_f32_16x16x32_bf16 v[184:187], v[100:103], v[88:91], v[184:187]
    ds_read_b64_tr_b16 v[120:121], v6 offset:46176
    v_mfma_f32_16x16x32_bf16 v[188:191], v[100:103], v[92:95], v[188:191]
    ds_read_b64_tr_b16 v[122:123], v6 offset:47136
    buffer_load_dwordx4 v[80:83], v4, s[20:23], s44 offen sc1
    s_waitcnt lgkmcnt(8)
    v_mfma_f32_16x16x32_bf16 v[136:139], v[104:107], v[88:91], v[136:139]
    ds_read_b64_tr_b16 v[96:97], v6 offset:53856
    v_mfma_f32_16x16x32_bf16 v[140:143], v[104:107], v[92:95], v[140:143]
    ds_read_b64_tr_b16 v[98:99], v6 offset:54816
    buffer_load_dwordx4 v[84:87], v4, s[20:23], s44 offen offset:1024 sc1
    s_add_u32 s44, s44, 2048
    s_waitcnt lgkmcnt(8)
    v_mfma_f32_16x16x32_bf16 v[192:195], v[108:111], v[88:91], v[192:195]
    ds_read_b64_tr_b16 v[100:101], v6 offset:46208
    v_mfma_f32_16x16x32_bf16 v[196:199], v[108:111], v[92:95], v[196:199]
    ds_read_b64_tr_b16 v[102:103], v6 offset:47168
    s_waitcnt lgkmcnt(8)
    v_mfma_f32_16x16x32_bf16 v[144:147], v[112:115], v[88:91], v[144:147]
    ds_read_b64_tr_b16 v[104:105], v6 offset:53888
    v_mfma_f32_16x16x32_bf16 v[148:151], v[112:115], v[92:95], v[148:151]
    ds_read_b64_tr_b16 v[106:107], v6 offset:54848
    s_add_u32 m0, s58, 76800
    s_mov_b64 exec, s[40:41]
    buffer_load_dwordx4 v3, s[8:11], s45 offen lds
    s_mov_b64 exec, -1
    s_waitcnt lgkmcnt(8)
    v_mfma_f32_16x16x32_bf16 v[200:203], v[116:119], v[88:91], v[200:203]
    ds_read_b64_tr_b16 v[108:109], v6 offset:46240
    v_mfma_f32_16x16x32_bf16 v[204:207], v[116:119], v[92:95], v[204:207]
    ds_read_b64_tr_b16 v[110:111], v6 offset:47200
    s_add_u32 m0, s58, 84480
    s_mov_b64 exec, s[40:41]
    buffer_load_dwordx4 v3, s[12:15], s45 offen lds
    s_mov_b64 exec, -1
    s_add_u32 s45, s45, 229376
    s_waitcnt lgkmcnt(8)
    v_mfma_f32_16x16x32_bf16 v[152:155], v[120:123], v[88:91], v[152:155]
    ds_read_b64_tr_b16 v[112:113], v6 offset:53920
    v_mfma_f32_16x16x32_bf16 v[156:159], v[120:123], v[92:95], v[156:159]
    ds_read_b64_tr_b16 v[114:115], v6 offset:54880
    s_waitcnt lgkmcnt(8)
    v_mfma_f32_16x16x32_bf16 v[208:211], v[96:99], v[88:91], v[208:211]
    ds_read_b64_tr_b16 v[116:117], v6 offset:46272
    v_mfma_f32_16x16x32_bf16 v[212:215], v[96:99], v[92:95], v[212:215]
    ds_read_b64_tr_b16 v[118:119], v6 offset:47232
    s_waitcnt lgkmcnt(8)
    v_mfma_f32_16x16x32_bf16 v[160:163], v[100:103], v[88:91], v[160:163]
    ds_read_b64_tr_b16 v[120:121], v6 offset:53952
    v_mfma_f32_16x16x32_bf16 v[164:167], v[100:103], v[92:95], v[164:167]
    ds_read_b64_tr_b16 v[122:123], v6 offset:54912
    s_waitcnt lgkmcnt(8)
    v_mfma_f32_16x16x32_bf16 v[216:219], v[104:107], v[88:91], v[216:219]
    ds_read_b64_tr_b16 v[96:97], v5 offset:0
    v_mfma_f32_16x16x32_bf16 v[220:223], v[104:107], v[92:95], v[220:223]
    ds_read_b64_tr_b16 v[98:99], v5 offset:960
    s_waitcnt lgkmcnt(8)
    v_mfma_f32_16x16x32_bf16 v[168:171], v[108:111], v[88:91], v[168:171]
    ds_read_b64_tr_b16 v[100:101], v5 offset:7680
    v_mfma_f32_16x16x32_bf16 v[172:175], v[108:111], v[92:95], v[172:175]
    ds_read_b64_tr_b16 v[102:103], v5 offset:8640
    s_waitcnt lgkmcnt(8)
    v_mfma_f32_16x16x32_bf16 v[224:227], v[112:115], v[88:91], v[224:227]
    ds_read_b64_tr_b16 v[104:105], v5 offset:32
    v_mfma_f32_16x16x32_bf16 v[228:231], v[112:115], v[92:95], v[228:231]
    ds_read_b64_tr_b16 v[106:107], v5 offset:992
    s_waitcnt lgkmcnt(8)
    v_mfma_f32_16x16x32_bf16 v[176:179], v[116:119], v[88:91], v[176:179]
    ds_read_b64_tr_b16 v[108:109], v5 offset:7712
    v_mfma_f32_16x16x32_bf16 v[180:183], v[116:119], v[92:95], v[180:183]
    ds_read_b64_tr_b16 v[110:111], v5 offset:8672
    s_waitcnt lgkmcnt(8)
    v_mfma_f32_16x16x32_bf16 v[232:235], v[120:123], v[88:91], v[232:235]
    ds_read_b64_tr_b16 v[112:113], v5 offset:64
    v_mfma_f32_16x16x32_bf16 v[236:239], v[120:123], v[92:95], v[236:239]
    ds_read_b64_tr_b16 v[114:115], v5 offset:1024
    s_sub_u32 s46, s46, 1
    s_cmp_lg_u32 s46, 0
    s_cbranch_scc1 K3_LOOP
    s_waitcnt lgkmcnt(0)
K3_EPI:
    v_and_b32 v7, 15, v2
    v_lshlrev_b32 v7, 4, v7
    v_bfe_u32 v8, v2, 4, 1
    v_lshl_add_u32 v7, v8, 10, v7
    v_lshrrev_b32 v8, 5, v2
    v_lshl_add_u32 v7, v8, 8, v7
    s_mul_i32 s57, s56, 229376
    v_add_u32 v7, s57, v7
    s_mul_i32 s59, s53, 7
    s_mov_b32 s66, 0xbdd2d3e8
    s_mov_b32 s67, 0xbdd2d3e8
    v_mov_b32 v8, 0xc0135761
    v_mov_b32 v9, 0xc0135761
    s_nop 7
    v_pk_mul_f32 v[16:17], v[128:129], v[128:129]
    v_pk_fma_f32 v[16:17], v[16:17], s[66:67], v[8:9]
    v_pk_mul_f32 v[16:17], v[16:17], v[128:129]
    v_exp_f32 v16, v16
    v_exp_f32 v17, v17
    v_pk_mul_f32 v[128:129], v[128:129], v[184:185]
    v_pk_add_f32 v[16:17], v[16:17], 1.0 op_sel_hi:[1,0]
    v_rcp_f32 v16, v16
    v_rcp_f32 v17, v17
    s_nop 0
    v_pk_mul_f32 v[128:129], v[128:129], v[16:17]
    v_cvt_pk_bf16_f32 v32, v128, v129
    v_pk_mul_f32 v[18:19], v[130:131], v[130:131]
    v_pk_fma_f32 v[18:19], v[18:19], s[66:67], v[8:9]
    v_pk_mul_f32 v[18:19], v[18:19], v[130:131]
    v_exp_f32 v18, v18
    v_exp_f32 v19, v19
    v_pk_mul_f32 v[130:131], v[130:131], v[186:187]
    v_pk_add_f32 v[18:19], v[18:19], 1.0 op_sel_hi:[1,0]
    v_rcp_f32 v18, v18
    v_rcp_f32 v19, v19
    s_nop 0
    v_pk_mul_f32 v[130:131], v[130:131], v[18:19]
    v_cvt_pk_bf16_f32 v33, v130, v131
    v_pk_mul_f32 v[20:21], v[132:133], v[132:133]
    v_pk_fma_f32 v[20:21], v[20:21], s[66:67], v[8:9]
    v_pk_mul_f32 v[20:21], v[20:21], v[132:133]
    v_exp_f32 v20, v20
    v_exp_f32 v21, v21
    v_pk_mul_f32 v[132:133], v[132:133], v[188:189]
    v_pk_add_f32 v[20:21], v[20:21], 1.0 op_sel_hi:[1,0]
    v_rcp_f32 v20, v20
    v_rcp_f32 v21, v21
    s_nop 0
    v_pk_mul_f32 v[132:133], v[132:133], v[20:21]
    v_cvt_pk_bf16_f32 v34, v132, v133
    v_pk_mul_f32 v[22:23], v[134:135], v[134:135]
    v_pk_fma_f32 v[22:23], v[22:23], s[66:67], v[8:9]
    v_pk_mul_f32 v[22:23], v[22:23], v[134:135]
    v_exp_f32 v22, v22
    v_exp_f32 v23, v23
    v_pk_mul_f32 v[134:135], v[134:135], v[190:191]
    v_pk_add_f32 v[22:23], v[22:23], 1.0 op_sel_hi:[1,0]
    v_rcp_f32 v22, v22
    v_rcp_f32 v23, v23
    s_nop 0
    v_pk_mul_f32 v[134:135], v[134:135], v[22:23]
    v_cvt_pk_bf16_f32 v35, v134, v135
    v_permlane16_swap_b32 v32, v34
    s_nop 0
    v_permlane16_swap_b32 v33, v35
    s_add_u32 s60, s59, 0
    s_lshr_b32 s61, s60, 1
    s_lshl_b32 s61, s61, 11
    s_and_b32 s60, s60, 1
    s_lshl_b32 s60, s60, 9
    s_add_u32 s60, s60, s61
    buffer_store_dwordx4 v[32:35], v7, s[24:27], s60 offen sc1
    v_pk_mul_f32 v[16:17], v[136:137], v[136:137]
    v_pk_fma_f32 v[16:17], v[16:17], s[66:67], v[8:9]
    v_pk_mul_f32 v[16:17], v[16:17], v[136:137]
    v_exp_f32 v16, v16
    v_exp_f32 v17, v17
    v_pk_mul_f32 v[136:137], v[136:137], v[192:193]
    v_pk_add_f32 v[16:17], v[16:17], 1.0 op_sel_hi:[1,0]
    v_rcp_f32 v16, v16
    v_rcp_f32 v17, v17
    s_nop 0
    v_pk_mul_f32 v[136:137], v[136:137], v[16:17]
    v_cvt_pk_bf16_f32 v36, v136, v137
    v_pk_mul_f32 v[18:19], v[138:139], v[138:139]
    v_pk_fma_f32 v[18:19], v[18:19], s[66:67], v[8:9]
    v_pk_mul_f32 v[18:19], v[18:19], v[138:139]
    v_exp_f32 v18, v18
    v_exp_f32 v19, v19
    v_pk_mul_f32 v[138:139], v[138:139], v[194:195]
    v_pk_add_f32 v[18:19], v[18:19], 1.0 op_sel_hi:[1,0]
    v_rcp_f32 v18, v18
    v_rcp_f32 v19, v19
    s_nop 0
    v_pk_mul_f32 v[138:139], v[138:139], v[18:19]
    v_cvt_pk_bf16_f32 v37, v138, v139
    v_pk_mul_f32 v[20:21], v[140:141], v[140:141]
    v_pk_fma_f32 v[20:21], v[20:21], s[66:67], v[8:9]
    v_pk_mul_f32 v[20:21], v[20:21], v[140:141]
    v_exp_f32 v20, v20
    v_exp_f32 v21, v21
    v_pk_mul_f32 v[140:141], v[140:141], v[196:197]
    v_pk_add_f32 v[20:21], v[20:21], 1.0 op_sel_hi:[1,0]
    v_rcp_f32 v20, v20
    v_rcp_f32 v21, v21
    s_nop 0
    v_pk_mul_f32 v[140:141], v[140:141], v[20:21]
    v_cvt_pk_bf16_f32 v38, v140, v141
    v_pk_mul_f32 v[22:23], v[142:143], v[142:143]
    v_pk_fma_f32 v[22:23], v[22:23], s[66:67], v[8:9]
    v_pk_mul_f32 v[22:23], v[22:23], v[142:143]
    v_exp_f32 v22, v22
    v_exp_f32 v23, v23
    v_pk_mul_f32 v[142:143], v[142:143], v[198:199]
    v_pk_add_f32 v[22:23], v[22:23], 1.0 op_sel_hi:[1,0]
    v_rcp_f32 v22, v22
    v_rcp_f32 v23, v23
    s_nop 0
    v_pk_mul_f32 v[142:143], v[142:143], v[22:23]
    v_cvt_pk_bf16_f32 v39, v142, v143
    v_permlane16_swap_b32 v36, v38
    s_nop 0
    v_permlane16_swap_b32 v37, v39
    s_add_u32 s60, s59, 1
    s_lshr_b32 s61, s60, 1
    s_lshl_b32 s61, s61, 11
    s_and_b32 s60, s60, 1
    s_lshl_b32 s60, s60, 9
    s_add_u32 s60, s60, s61
    buffer_store_dwordx4 v[36:39], v7, s[24:27], s60 offen sc1
    v_pk_mul_f32 v[16:17], v[144:145], v[144:145]
    v_pk_fma_f32 v[16:17], v[16:17], s[66:67], v[8:9]
    v_pk_mul_f32 v[16:17], v[16:17], v[144:145]
    v_exp_f32 v16, v16
    v_exp_f32 v17, v17
    v_pk_mul_f32 v[144:145], v[144:145], v[200:201]
    v_pk_add_f32 v[16:17], v[16:17], 1.0 op_sel_hi:[1,0]
    v_rcp_f32 v16, v16
    v_rcp_f32 v17, v17
    s_nop 0
    v_pk_mul_f32 v[144:145], v[144:145], v[16:17]
    v_cvt_pk_bf16_f32 v40, v144, v145
    v_pk_mul_f32 v[18:19], v[146:147], v[146:147]
    v_pk_fma_f32 v[18:19], v[18:19], s[66:67], v[8:9]
    v_pk_mul_f32 v[18:19], v[18:19], v[146:147]
    v_exp_f32 v18, v18
    v_exp_f32 v19, v19
    v_pk_mul_f32 v[146:147], v[146:147], v[202:203]
    v_pk_add_f32 v[18:19], v[18:19], 1.0 op_sel_hi:[1,0]
    v_rcp_f32 v18, v18
    v_rcp_f32 v19, v19
    s_nop 0
    v_pk_mul_f32 v[146:147], v[146:147], v[18:19]
    v_cvt_pk_bf16_f32 v41, v146, v147
    v_pk_mul_f32 v[20:21], v[148:149], v[148:149]
    v_pk_fma_f32 v[20:21], v[20:21], s[66:67], v[8:9]
    v_pk_mul_f32 v[20:21], v[20:21], v[148:149]
    v_exp_f32 v20, v20
    v_exp_f32 v21, v21
    v_pk_mul_f32 v[148:149], v[148:149], v[204:205]
    v_pk_add_f32 v[20:21], v[20:21], 1.0 op_sel_hi:[1,0]
    v_rcp_f32 v20, v20
    v_rcp_f32 v21, v21
    s_nop 0
    v_pk_mul_f32 v[148:149], v[148:149], v[20:21]
    v_cvt_pk_bf16_f32 v42, v148, v149
    v_pk_mul_f32 v[22:23], v[150:151], v[150:151]
    v_pk_fma_f32 v[22:23], v[22:23], s[66:67], v[8:9]
    v_pk_mul_f32 v[22:23], v[22:23], v[150:151]
    v_exp_f32 v22, v22
    v_exp_f32 v23, v23
    v_pk_mul_f32 v[150:151], v[150:151], v[206:207]
    v_pk_add_f32 v[22:23], v[22:23], 1.0 op_sel_hi:[1,0]
    v_rcp_f32 v22, v22
    v_rcp_f32 v23, v23
    s_nop 0
    v_pk_mul_f32 v[150:151], v[150:151], v[22:23]
    v_cvt_pk_bf16_f32 v43, v150, v151
    v_permlane16_swap_b32 v40, v42
    s_nop 0
    v_permlane16_swap_b32 v41, v43
    s_add_u32 s60, s59, 2
    s_lshr_b32 s61, s60, 1
    s_lshl_b32 s61, s61, 11
    s_and_b32 s60, s60, 1
    s_lshl_b32 s60, s60, 9
    s_add_u32 s60, s60, s61
    buffer_store_dwordx4 v[40:43], v7, s[24:27], s60 offen sc1
    v_pk_mul_f32 v[16:17], v[152:153], v[152:153]
    v_pk_fma_f32 v[16:17], v[16:17], s[66:67], v[8:9]
    v_pk_mul_f32 v[16:17], v[16:17], v[152:153]
    v_exp_f32 v16, v16
    v_exp_f32 v17, v17
    v_pk_mul_f32 v[152:153], v[152:153], v[208:209]
    v_pk_add_f32 v[16:17], v[16:17], 1.0 op_sel_hi:[1,0]
    v_rcp_f32 v16, v16
    v_rcp_f32 v17, v17
    s_nop 0
    v_pk_mul_f32 v[152:153], v[152:153], v[16:17]
    v_cvt_pk_bf16_f32 v44, v152, v153
    v_pk_mul_f32 v[18:19], v[154:155], v[154:155]
    v_pk_fma_f32 v[18:19], v[18:19], s[66:67], v[8:9]
    v_pk_mul_f32 v[18:19], v[18:19], v[154:155]
    v_exp_f32 v18, v18
    v_exp_f32 v19, v19
    v_pk_mul_f32 v[154:155], v[154:155], v[210:211]
    v_pk_add_f32 v[18:19], v[18:19], 1.0 op_sel_hi:[1,0]
    v_rcp_f32 v18, v18
    v_rcp_f32 v19, v19
    s_nop 0
    v_pk_mul_f32 v[154:155], v[154:155], v[18:19]
    v_cvt_pk_bf16_f32 v45, v154, v155
    v_pk_mul_f32 v[20:21], v[156:157], v[156:157]
    v_pk_fma_f32 v[20:21], v[20:21], s[66:67], v[8:9]
    v_pk_mul_f32 v[20:21], v[20:21], v[156:157]
    v_exp_f32 v20, v20
    v_exp_f32 v21, v21
    v_pk_mul_f32 v[156:157], v[156:157], v[212:213]
    v_pk_add_f32 v[20:21], v[20:21], 1.0 op_sel_hi:[1,0]
    v_rcp_f32 v20, v20
    v_rcp_f32 v21, v21
    s_nop 0
    v_pk_mul_f32 v[156:157], v[156:157], v[20:21]
    v_cvt_pk_bf16_f32 v46, v156, v157
    v_pk_mul_f32 v[22:23], v[158:159], v[158:159]
    v_pk_fma_f32 v[22:23], v[22:23], s[66:67], v[8:9]
    v_pk_mul_f32 v[22:23], v[22:23], v[158:159]
    v_exp_f32 v22, v22
    v_exp_f32 v23, v23
    v_pk_mul_f32 v[158:159], v[158:159], v[214:215]
    v_pk_add_f32 v[22:23], v[22:23], 1.0 op_sel_hi:[1,0]
    v_rcp_f32 v22, v22
    v_rcp_f32 v23, v23
    s_nop 0
    v_pk_mul_f32 v[158:159], v[158:159], v[22:23]
    v_cvt_pk_bf16_f32 v47, v158, v159
    v_permlane16_swap_b32 v44, v46
    s_nop 0
    v_permlane16_swap_b32 v45, v47
    s_add_u32 s60, s59, 3
    s_lshr_b32 s61, s60, 1
    s_lshl_b32 s61, s61, 11
    s_and_b32 s60, s60, 1
    s_lshl_b32 s60, s60, 9
    s_add_u32 s60, s60, s61
    buffer_store_dwordx4 v[44:47], v7, s[24:27], s60 offen sc1
    v_pk_mul_f32 v[16:17], v[160:161], v[160:161]
    v_pk_fma_f32 v[16:17], v[16:17], s[66:67], v[8:9]
    v_pk_mul_f32 v[16:17], v[16:17], v[160:161]
    v_exp_f32 v16, v16
    v_exp_f32 v17, v17
    v_pk_mul_f32 v[160:161], v[160:161], v[216:217]
    v_pk_add_f32 v[16:17], v[16:17], 1.0 op_sel_hi:[1,0]
    v_rcp_f32 v16, v16
    v_rcp_f32 v17, v17
    s_nop 0
    v_pk_mul_f32 v[160:161], v[160:161], v[16:17]
    v_cvt_pk_bf16_f32 v32, v160, v161
    v_pk_mul_f32 v[18:19], v[162:163], v[162:163]
    v_pk_fma_f32 v[18:19], v[18:19], s[66:67], v[8:9]
    v_pk_mul_f32 v[18:19], v[18:19], v[162:163]
    v_exp_f32 v18, v18
    v_exp_f32 v19, v19
    v_pk_mul_f32 v[162:163], v[162:163], v[218:219]
    v_pk_add_f32 v[18:19], v[18:19], 1.0 op_sel_hi:[1,0]
    v_rcp_f32 v18, v18
    v_rcp_f32 v19, v19
    s_nop 0
    v_pk_mul_f32 v[162:163], v[162:163], v[18:19]
    v_cvt_pk_bf16_f32 v33, v162, v163
    v_pk_mul_f32 v[20:21], v[164:165], v[164:165]
    v_pk_fma_f32 v[20:21], v[20:21], s[66:67], v[8:9]
    v_pk_mul_f32 v[20:21], v[20:21], v[164:165]
    v_exp_f32 v20, v20
    v_exp_f32 v21, v21
    v_pk_mul_f32 v[164:165], v[164:165], v[220:221]
    v_pk_add_f32 v[20:21], v[20:21], 1.0 op_sel_hi:[1,0]
    v_rcp_f32 v20, v20
    v_rcp_f32 v21, v21
    s_nop 0
    v_pk_mul_f32 v[164:165], v[164:165], v[20:21]
    v_cvt_pk_bf16_f32 v34, v164, v165
    v_pk_mul_f32 v[22:23], v[166:167], v[166:167]
    v_pk_fma_f32 v[22:23], v[22:23], s[66:67], v[8:9]
    v_pk_mul_f32 v[22:23], v[22:23], v[166:167]
    v_exp_f32 v22, v22
    v_exp_f32 v23, v23
    v_pk_mul_f32 v[166:167], v[166:167], v[222:223]
    v_pk_add_f32 v[22:23], v[22:23], 1.0 op_sel_hi:[1,0]
    v_rcp_f32 v22, v22
    v_rcp_f32 v23, v23
    s_nop 0
    v_pk_mul_f32 v[166:167], v[166:167], v[22:23]
    v_cvt_pk_bf16_f32 v35, v166, v167
    v_permlane16_swap_b32 v32, v34
    s_nop 0
    v_permlane16_swap_b32 v33, v35
    s_add_u32 s60, s59, 4
    s_lshr_b32 s61, s60, 1
    s_lshl_b32 s61, s61, 11
    s_and_b32 s60, s60, 1
    s_lshl_b32 s60, s60, 9
    s_add_u32 s60, s60, s61
    buffer_store_dwordx4 v[32:35], v7, s[24:27], s60 offen sc1
    v_pk_mul_f32 v[16:17], v[168:169], v[168:169]
    v_pk_fma_f32 v[16:17], v[16:17], s[66:67], v[8:9]
    v_pk_mul_f32 v[16:17], v[16:17], v[168:169]
    v_exp_f32 v16, v16
    v_exp_f32 v17, v17
    v_pk_mul_f32 v[168:169], v[168:169], v[224:225]
    v_pk_add_f32 v[16:17], v[16:17], 1.0 op_sel_hi:[1,0]
    v_rcp_f32 v16, v16
    v_rcp_f32 v17, v17
    s_nop 0
    v_pk_mul_f32 v[168:169], v[168:169], v[16:17]
    v_cvt_pk_bf16_f32 v36, v168, v169
    v_pk_mul_f32 v[18:19], v[170:171], v[170:171]
    v_pk_fma_f32 v[18:19], v[18:19], s[66:67], v[8:9]
    v_pk_mul_f32 v[18:19], v[18:19], v[170:171]
    v_exp_f32 v18, v18
    v_exp_f32 v19, v19
    v_pk_mul_f32 v[170:171], v[170:171], v[226:227]
    v_pk_add_f32 v[18:19], v[18:19], 1.0 op_sel_hi:[1,0]
    v_rcp_f32 v18, v18
    v_rcp_f32 v19, v19
    s_nop 0
    v_pk_mul_f32 v[170:171], v[170:171], v[18:19]
    v_cvt_pk_bf16_f32 v37, v170, v171
    v_pk_mul_f32 v[20:21], v[172:173], v[172:173]
    v_pk_fma_f32 v[20:21], v[20:21], s[66:67], v[8:9]
    v_pk_mul_f32 v[20:21], v[20:21], v[172:173]
    v_exp_f32 v20, v20
    v_exp_f32 v21, v21
    v_pk_mul_f32 v[172:173], v[172:173], v[228:229]
    v_pk_add_f32 v[20:21], v[20:21], 1.0 op_sel_hi:[1,0]
    v_rcp_f32 v20, v20
    v_rcp_f32 v21, v21
    s_nop 0
    v_pk_mul_f32 v[172:173], v[172:173], v[20:21]
    v_cvt_pk_bf16_f32 v38, v172, v173
    v_pk_mul_f32 v[22:23], v[174:175], v[174:175]
    v_pk_fma_f32 v[22:23], v[22:23], s[66:67], v[8:9]
    v_pk_mul_f32 v[22:23], v[22:23], v[174:175]
    v_exp_f32 v22, v22
    v_exp_f32 v23, v23
    v_pk_mul_f32 v[174:175], v[174:175], v[230:231]
    v_pk_add_f32 v[22:23], v[22:23], 1.0 op_sel_hi:[1,0]
    v_rcp_f32 v22, v22
    v_rcp_f32 v23, v23
    s_nop 0
    v_pk_mul_f32 v[174:175], v[174:175], v[22:23]
    v_cvt_pk_bf16_f32 v39, v174, v175
    v_permlane16_swap_b32 v36, v38
    s_nop 0
    v_permlane16_swap_b32 v37, v39
    s_add_u32 s60, s59, 5
    s_lshr_b32 s61, s60, 1
    s_lshl_b32 s61, s61, 11
    s_and_b32 s60, s60, 1
    s_lshl_b32 s60, s60, 9
    s_add_u32 s60, s60, s61
    buffer_store_dwordx4 v[36:39], v7, s[24:27], s60 offen sc1
    v_pk_mul_f32 v[16:17], v[176:177], v[176:177]
    v_pk_fma_f32 v[16:17], v[16:17], s[66:67], v[8:9]
    v_pk_mul_f32 v[16:17], v[16:17], v[176:177]
    v_exp_f32 v16, v16
    v_exp_f32 v17, v17
    v_pk_mul_f32 v[176:177], v[176:177], v[232:233]
    v_pk_add_f32 v[16:17], v[16:17], 1.0 op_sel_hi:[1,0]
    v_rcp_f32 v16, v16
    v_rcp_f32 v17, v17
    s_nop 0
    v_pk_mul_f32 v[176:177], v[176:177], v[16:17]
    v_cvt_pk_bf16_f32 v40, v176, v177
    v_pk_mul_f32 v[18:19], v[178:179], v[178:179]
    v_pk_fma_f32 v[18:19], v[18:19], s[66:67], v[8:9]
    v_pk_mul_f32 v[18:19], v[18:19], v[178:179]
    v_exp_f32 v18, v18
    v_exp_f32 v19, v19
    v_pk_mul_f32 v[178:179], v[178:179], v[234:235]
    v_pk_add_f32 v[18:19], v[18:19], 1.0 op_sel_hi:[1,0]
    v_rcp_f32 v18, v18
    v_rcp_f32 v19, v19
    s_nop 0
    v_pk_mul_f32 v[178:179], v[178:179], v[18:19]
    v_cvt_pk_bf16_f32 v41, v178, v179
    v_pk_mul_f32 v[20:21], v[180:181], v[180:181]
    v_pk_fma_f32 v[20:21], v[20:21], s[66:67], v[8:9]
    v_pk_mul_f32 v[20:21], v[20:21], v[180:181]
    v_exp_f32 v20, v20
    v_exp_f32 v21, v21
    v_pk_mul_f32 v[180:181], v[180:181], v[236:237]
    v_pk_add_f32 v[20:21], v[20:21], 1.0 op_sel_hi:[1,0]
    v_rcp_f32 v20, v20
    v_rcp_f32 v21, v21
    s_nop 0
    v_pk_mul_f32 v[180:181], v[180:181], v[20:21]
    v_cvt_pk_bf16_f32 v42, v180, v181
    v_pk_mul_f32 v[22:23], v[182:183], v[182:183]
    v_pk_fma_f32 v[22:23], v[22:23], s[66:67], v[8:9]
    v_pk_mul_f32 v[22:23], v[22:23], v[182:183]
    v_exp_f32 v22, v22
    v_exp_f32 v23, v23
    v_pk_mul_f32 v[182:183], v[182:183], v[238:239]
    v_pk_add_f32 v[22:23], v[22:23], 1.0 op_sel_hi:[1,0]
    v_rcp_f32 v22, v22
    v_rcp_f32 v23, v23
    s_nop 0
    v_pk_mul_f32 v[182:183], v[182:183], v[22:23]
    v_cvt_pk_bf16_f32 v43, v182, v183
    v_permlane16_swap_b32 v40, v42
    s_nop 0
    v_permlane16_swap_b32 v41, v43
    s_add_u32 s60, s59, 6
    s_lshr_b32 s61, s60, 1
    s_lshl_b32 s61, s61, 11
    s_and_b32 s60, s60, 1
    s_lshl_b32 s60, s60, 9
    s_add_u32 s60, s60, s61
    buffer_store_dwordx4 v[40:43], v7, s[24:27], s60 offen sc1
K3_END:
FE_END:
    s_endpgm
.globl ffn2_kernel
.p2align 8
.type ffn2_kernel,@function
ffn2_kernel:
    s_cmp_ge_u32 s2, 256
    s_cbranch_scc1 K4_END
    s_load_dwordx2 s[4:5], s[0:1], 72
    s_load_dwordx2 s[6:7], s[0:1], 96
    s_load_dwordx2 s[28:29], s[0:1], 112
    v_lshrrev_b32 v1, 6, v0
    s_mov_b32 s63, 0xffff0000
    v_readfirstlane_b32 s62, v1
    v_and_b32 v2, 63, v0
    s_and_b32 s50, s2, 7
    s_lshr_b32 s51, s2, 3
    s_and_b32 s52, s50, 3
    s_lshl_b32 s52, s52, 2
    s_and_b32 s53, s51, 3
    s_add_u32 s52, s52, s53
    s_lshr_b32 s53, s50, 2
    s_lshl_b32 s53, s53, 3
    s_lshr_b32 s54, s51, 2
    s_add_u32 s53, s53, s54
    s_waitcnt lgkmcnt(0)
    s_add_u32 s8, s28, 41943040
    s_addc_u32 s9, s29, 0
    s_mov_b32 s10, 7340032
    s_mov_b32 s11, 0x00020000
    s_mov_b32 s12, s6
    s_mov_b32 s13, s7
    s_mov_b32 s14, 4194304
    s_mov_b32 s15, 0x00020000
    s_add_u32 s16, s28, 19922944
    s_addc_u32 s17, s29, 0
    s_mov_b32 s18, 14680064
    s_mov_b32 s19, 0x00020000
    s_add_u32 s20, s28, 6291456
    s_addc_u32 s21, s29, 0
    s_mov_b32 s22, 4194304
    s_mov_b32 s23, 0x00020000
    s_add_u32 s24, s28, 32768
    s_addc_u32 s25, s29, 0
    s_mov_b32 s26, 24576
    s_mov_b32 s27, 0x00020000
    s_and_b32 s55, s62, 3
    s_lshr_b32 s56, s62, 2
    s_mul_i32 s57, s53, 458752
    s_lshl_b32 s59, s62, 11
    s_add_u32 s57, s57, s59
    v_lshlrev_b32 v10, 4, v2
    v_add_u32 v3, s57, v10
    v_add_u32 v4, 1024, v3
    s_lshl_b32 s57, s52, 2
    s_add_u32 s57, s57, s55
    s_mul_i32 s57, s57, 229376
    s_lshl_b32 s58, s56, 12
    s_add_u32 s57, s57, s58
    v_lshlrev_b32 v10, 4, v2
    v_add_u32 v5, s57, v10
    v_lshrrev_b32 v10, 4, v2
    v_bfe_u32 v11, v2, 2, 2
    v_lshl_add_u32 v12, v10, 3, v11
    v_lshlrev_b32 v12, 7, v12
    v_lshrrev_b32 v11, 1, v11
    v_and_b32 v10, 1, v10
    v_lshl_or_b32 v11, v10, 1, v11
    v_lshl_add_u32 v12, v11, 5, v12
    v_and_b32 v11, 3, v2
    v_lshl_add_u32 v12, v11, 3, v12
    s_lshl_b32 s58, s56, 13
    v_add_u32 v12, s58, v12
    v_xor_b32 v16, 0, v12
    v_xor_b32 v17, 32, v12
    v_xor_b32 v18, 64, v12
    v_xor_b32 v19, 96, v12
    s_lshl_b32 s58, s62, 11
    s_mov_b32 s44, 0
    s_mov_b32 s45, 0
    s_add_u32 s32, s28, 19922944
    s_addc_u32 s33, s29, 0
    s_mov_b32 s34, 14680064
    s_mov_b32 s35, 0x00020000
    s_add_u32 s36, s28, 19922944
    s_addc_u32 s37, s29, 0
    s_mov_b32 s38, 0
    s_mov_b32 s39, 0x00020000
    s_add_u32 s40, s28, 41943040
    s_addc_u32 s41, s29, 0
    s_mov_b32 s42, 7340032
    s_mov_b32 s43, 0x00020000
    s_add_u32 s68, s28, 19922944
    s_addc_u32 s69, s29, 0
    s_mov_b32 s70, 14680064
    s_mov_b32 s71, 0x00020000
    s_add_u32 s72, s28, 41943040
    s_addc_u32 s73, s29, 0
    s_mov_b32 s74, 7340032
    s_mov_b32 s75, 0x00020000
    s_add_u32 m0, s58, 0
    s_nop 0
    buffer_load_dwordx4 v3, s[8:11], s45 offen lds
    s_add_u32 m0, s58, 1024
    s_nop 0
    buffer_load_dwordx4 v4, s[8:11], s45 offen lds
    s_add_u32 s45, s45, 16384
    buffer_load_dwordx4 v[32:35], v5, s[16:19], s44 offen offset:0
    buffer_load_dwordx4 v[36:39], v5, s[16:19], s44 offen offset:1024
    buffer_load_dwordx4 v[40:43], v5, s[16:19], s44 offen offset:2048
    buffer_load_dwordx4 v[44:47], v5, s[16:19], s44 offen offset:3072
    s_add_u32 s44, s44, 8192
    s_barrier
    s_add_u32 m0, s58, 16384
    s_nop 0
    buffer_load_dwordx4 v3, s[8:11], s45 offen lds
    s_add_u32 m0, s58, 17408
    s_nop 0
    buffer_load_dwordx4 v4, s[8:11], s45 offen lds
    s_add_u32 s45, s45, 16384
    buffer_load_dwordx4 v[48:51], v5, s[16:19], s44 offen offset:0
    buffer_load_dwordx4 v[52:55], v5, s[16:19], s44 offen offset:1024
    buffer_load_dwordx4 v[56:59], v5, s[16:19], s44 offen offset:2048
    buffer_load_dwordx4 v[60:63], v5, s[16:19], s44 offen offset:3072
    s_add_u32 s44, s44, 8192
    v_mov_b32 v128, 0
    v_mov_b32 v129, 0
    v_mov_b32 v130, 0
    v_mov_b32 v131, 0
    v_mov_b32 v132, 0
    v_mov_b32 v133, 0
    v_mov_b32 v134, 0
    v_mov_b32 v135, 0
    v_mov_b32 v136, 0
    v_mov_b32 v137, 0
    v_mov_b32 v138, 0
    v_mov_b32 v139, 0
    v_mov_b32 v140, 0
    v_mov_b32 v141, 0
    v_mov_b32 v142, 0
    v_mov_b32 v143, 0
    v_mov_b32 v144, 0
    v_mov_b32 v145, 0
    v_mov_b32 v146, 0
    v_mov_b32 v147, 0
    v_mov_b32 v148, 0
    v_mov_b32 v149, 0
    v_mov_b32 v150, 0
    v_mov_b32 v151, 0
    v_mov_b32 v152, 0
    v_mov_b32 v153, 0
    v_mov_b32 v154, 0
    v_mov_b32 v155, 0
    v_mov_b32 v156, 0
    v_mov_b32 v157, 0
    v_mov_b32 v158, 0
    v_mov_b32 v159, 0
    s_mov_b32 s46, 7
K4_LOOP:
    s_cmp_eq_u32 s46, 1
    s_cselect_b32 s34, 0, 14680064
    s_cselect_b32 s42, 0, 7340032
    s_waitcnt vmcnt(6)
    s_barrier
    ds_read_b64_tr_b16 v[96:97], v16 offset:0
    ds_read_b64_tr_b16 v[98:99], v16 offset:512
    ds_read_b64_tr_b16 v[100:101], v17 offset:0
    ds_read_b64_tr_b16 v[102:103], v17 offset:512
    ds_read_b64_tr_b16 v[104:105], v18 offset:0
    ds_read_b64_tr_b16 v[106:107], v18 offset:512
    ds_read_b64_tr_b16 v[108:109], v19 offset:0
    ds_read_b64_tr_b16 v[110:111], v19 offset:512
    s_add_u32 m0, s58, 32768
    s_nop 0
    buffer_load_dwordx4 v3, s[8:11], s45 offen lds
    s_waitcnt lgkmcnt(6)
    v_mfma_f32_16x16x32_bf16 v[128:131], v[96:99], v[32:35], v[128:131]
    ds_read_b64_tr_b16 v[112:113], v16 offset:4096
    v_mfma_f32_16x16x32_bf16 v[132:135], v[96:99], v[36:39], v[132:135]
    ds_read_b64_tr_b16 v[114:115], v16 offset:4608
    buffer_load_dwordx4 v[64:67], v5, s[16:19], s44 offen offset:0
    s_waitcnt lgkmcnt(6)
    v_mfma_f32_16x16x32_bf16 v[136:139], v[100:103], v[32:35], v[136:139]
    ds_read_b64_tr_b16 v[116:117], v17 offset:4096
    v_mfma_f32_16x16x32_bf16 v[140:143], v[100:103], v[36:39], v[140:143]
    ds_read_b64_tr_b16 v[118:119], v17 offset:4608
    buffer_load_dwordx4 v[68:71], v5, s[16:19], s44 offen offset:1024
    s_waitcnt lgkmcnt(6)
    v_mfma_f32_16x16x32_bf16 v[144:147], v[104:107], v[32:35], v[144:147]
    ds_read_b64_tr_b16 v[120:121], v18 offset:4096
    v_mfma_f32_16x16x32_bf16 v[148:151], v[104:107], v[36:39], v[148:151]
    ds_read_b64_tr_b16 v[122:123], v18 offset:4608
    s_add_u32 m0, s58, 33792
    s_nop 0
    buffer_load_dwordx4 v4, s[8:11], s45 offen lds
    s_add_u32 s45, s45, 16384
    s_waitcnt lgkmcnt(6)
    v_mfma_f32_16x16x32_bf16 v[152:155], v[108:111], v[32:35], v[152:155]
    ds_read_b64_tr_b16 v[124:125], v19 offset:4096
    v_mfma_f32_16x16x32_bf16 v[156:159], v[108:111], v[36:39], v[156:159]
    ds_read_b64_tr_b16 v[126:127], v19 offset:4608
    buffer_load_dwordx4 v[72:75], v5, s[16:19], s44 offen offset:2048
    s_waitcnt lgkmcnt(6)
    v_mfma_f32_16x16x32_bf16 v[128:131], v[112:115], v[40:43], v[128:131]
    v_mfma_f32_16x16x32_bf16 v[132:135], v[112:115], v[44:47], v[132:135]
    buffer_load_dwordx4 v[76:79], v5, s[16:19], s44 offen offset:3072
    s_add_u32 s44, s44, 8192
    s_waitcnt lgkmcnt(4)
    v_mfma_f32_16x16x32_bf16 v[136:139], v[116:119], v[40:43], v[136:139]
    v_mfma_f32_16x16x32_bf16 v[140:143], v[116:119], v[44:47], v[140:143]
    s_waitcnt lgkmcnt(2)
    v_mfma_f32_16x16x32_bf16 v[144:147], v[120:123], v[40:43], v[144:147]
    v_mfma_f32_16x16x32_bf16 v[148:151], v[120:123], v[44:47], v[148:151]
    s_waitcnt lgkmcnt(0)
    v_mfma_f32_16x16x32_bf16 v[152:155], v[124:127], v[40:43], v[152:155]
    v_mfma_f32_16x16x32_bf16 v[156:159], v[124:127], v[44:47], v[156:159]
    s_waitcnt vmcnt(6)
    s_barrier
    ds_read_b64_tr_b16 v[96:97], v16 offset:16384
    ds_read_b64_tr_b16 v[98:99], v16 offset:16896
    ds_read_b64_tr_b16 v[100:101], v17 offset:16384
    ds_read_b64_tr_b16 v[102:103], v17 offset:16896
    ds_read_b64_tr_b16 v[104:105], v18 offset:16384
    ds_read_b64_tr_b16 v[106:107], v18 offset:16896
    ds_read_b64_tr_b16 v[108:109], v19 offset:16384
    ds_read_b64_tr_b16 v[110:111], v19 offset:16896
    s_add_u32 m0, s58, 49152
    s_nop 0
    buffer_load_dwordx4 v3, s[8:11], s45 offen lds
    s_waitcnt lgkmcnt(6)
    v_mfma_f32_16x16x32_bf16 v[128:131], v[96:99], v[48:51], v[128:131]
    ds_read_b64_tr_b16 v[112:113], v16 offset:20480
    v_mfma_f32_16x16x32_bf16 v[132:135], v[96:99], v[52:55], v[132:135]
    ds_read_b64_tr_b16 v[114:115], v16 offset:20992
    buffer_load_dwordx4 v[80:83], v5, s[16:19], s44 offen offset:0
    s_waitcnt lgkmcnt(6)
    v_mfma_f32_16x16x32_bf16 v[136:139], v[100:103], v[48:51], v[136:139]
    ds_read_b64_tr_b16 v[116:117], v17 offset:20480
    v_mfma_f32_16x16x32_bf16 v[140:143], v[100:103], v[52:55], v[140:143]
    ds_read_b64_tr_b16 v[118:119], v17 offset:20992
    buffer_load_dwordx4 v[84:87], v5, s[16:19], s44 offen offset:1024
    s_waitcnt lgkmcnt(6)
    v_mfma_f32_16x16x32_bf16 v[144:147], v[104:107], v[48:51], v[144:147]
    ds_read_b64_tr_b16 v[120:121], v18 offset:20480
    v_mfma_f32_16x16x32_bf16 v[148:151], v[104:107], v[52:55], v[148:151]
    ds_read_b64_tr_b16 v[122:123], v18 offset:20992
    s_add_u32 m0, s58, 50176
    s_nop 0
    buffer_load_dwordx4 v4, s[8:11], s45 offen lds
    s_add_u32 s45, s45, 16384
    s_waitcnt lgkmcnt(6)
    v_mfma_f32_16x16x32_bf16 v[152:155], v[108:111], v[48:51], v[152:155]
    ds_read_b64_tr_b16 v[124:125], v19 offset:20480
    v_mfma_f32_16x16x32_bf16 v[156:159], v[108:111], v[52:55], v[156:159]
    ds_read_b64_tr_b16 v[126:127], v19 offset:20992
    buffer_load_dwordx4 v[88:91], v5, s[16:19], s44 offen offset:2048
    s_waitcnt lgkmcnt(6)
    v_mfma_f32_16x16x32_bf16 v[128:131], v[112:115], v[56:59], v[128:131]
    v_mfma_f32_16x16x32_bf16 v[132:135], v[112:115], v[60:63], v[132:135]
    buffer_load_dwordx4 v[92:95], v5, s[16:19], s44 offen offset:3072
    s_add_u32 s44, s44, 8192
    s_waitcnt lgkmcnt(4)
    v_mfma_f32_16x16x32_bf16 v[136:139], v[116:119], v[56:59], v[136:139]
    v_mfma_f32_16x16x32_bf16 v[140:143], v[116:119], v[60:63], v[140:143]
    s_waitcnt lgkmcnt(2)
    v_mfma_f32_16x16x32_bf16 v[144:147], v[120:123], v[56:59], v[144:147]
    v_mfma_f32_16x16x32_bf16 v[148:151], v[120:123], v[60:63], v[148:151]
    s_waitcnt lgkmcnt(0)
    v_mfma_f32_16x16x32_bf16 v[152:155], v[124:127], v[56:59], v[152:155]
    v_mfma_f32_16x16x32_bf16 v[156:159], v[124:127], v[60:63], v[156:159]
    s_waitcnt vmcnt(6)
    s_barrier
    ds_read_b64_tr_b16 v[96:97], v16 offset:32768
    ds_read_b64_tr_b16 v[98:99], v16 offset:33280
    ds_read_b64_tr_b16 v[100:101], v17 offset:32768
    ds_read_b64_tr_b16 v[102:103], v17 offset:33280
    ds_read_b64_tr_b16 v[104:105], v18 offset:32768
    ds_read_b64_tr_b16 v[106:107], v18 offset:33280
    ds_read_b64_tr_b16 v[108:109], v19 offset:32768
    ds_read_b64_tr_b16 v[110:111], v19 offset:33280
    s_add_u32 m0, s58, 0
    s_nop 0
    buffer_load_dwordx4 v3, s[40:43], s45 offen lds
    s_waitcnt lgkmcnt(6)
    v_mfma_f32_16x16x32_bf16 v[128:131], v[96:99], v[64:67], v[128:131]
    ds_read_b64_tr_b16 v[112:113], v16 offset:36864
    v_mfma_f32_16x16x32_bf16 v[132:135], v[96:99], v[68:71], v[132:135]
    ds_read_b64_tr_b16 v[114:115], v16 offset:37376
    buffer_load_dwordx4 v[32:35], v5, s[32:35], s44 offen offset:0
    s_waitcnt lgkmcnt(6)
    v_mfma_f32_16x16x32_bf16 v[136:139], v[100:103], v[64:67], v[136:139]
    ds_read_b64_tr_b16 v[116:117], v17 offset:36864
    v_mfma_f32_16x16x32_bf16 v[140:143], v[100:103], v[68:71], v[140:143]
    ds_read_b64_tr_b16 v[118:119], v17 offset:37376
    buffer_load_dwordx4 v[36:39], v5, s[32:35], s44 offen offset:1024
    s_waitcnt lgkmcnt(6)
    v_mfma_f32_16x16x32_bf16 v[144:147], v[104:107], v[64:67], v[144:147]
    ds_read_b64_tr_b16 v[120:121], v18 offset:36864
    v_mfma_f32_16x16x32_bf16 v[148:151], v[104:107], v[68:71], v[148:151]
    ds_read_b64_tr_b16 v[122:123], v18 offset:37376
    s_add_u32 m0, s58, 1024
    s_nop 0
    buffer_load_dwordx4 v4, s[40:43], s45 offen lds
    s_add_u32 s45, s45, 16384
    s_waitcnt lgkmcnt(6)
    v_mfma_f32_16x16x32_bf16 v[152:155], v[108:111], v[64:67], v[152:155]
    ds_read_b64_tr_b16 v[124:125], v19 offset:36864
    v_mfma_f32_16x16x32_bf16 v[156:159], v[108:111], v[68:71], v[156:159]
    ds_read_b64_tr_b16 v[126:127], v19 offset:37376
    buffer_load_dwordx4 v[40:43], v5, s[32:35], s44 offen offset:2048
    s_waitcnt lgkmcnt(6)
    v_mfma_f32_16x16x32_bf16 v[128:131], v[112:115], v[72:75], v[128:131]
    v_mfma_f32_16x16x32_bf16 v[132:135], v[112:115], v[76:79], v[132:135]
    buffer_load_dwordx4 v[44:47], v5, s[32:35], s44 offen offset:3072
    s_add_u32 s44, s44, 8192
    s_waitcnt lgkmcnt(4)
    v_mfma_f32_16x16x32_bf16 v[136:139], v[116:119], v[72:75], v[136:139]
    v_mfma_f32_16x16x32_bf16 v[140:143], v[116:119], v[76:79], v[140:143]
    s_waitcnt lgkmcnt(2)
    v_mfma_f32_16x16x32_bf16 v[144:147], v[120:123], v[72:75], v[144:147]
    v_mfma_f32_16x16x32_bf16 v[148:151], v[120:123], v[76:79], v[148:151]
    s_waitcnt lgkmcnt(0)
    v_mfma_f32_16x16x32_bf16 v[152:155], v[124:127], v[72:75], v[152:155]
    v_mfma_f32_16x16x32_bf16 v[156:159], v[124:127], v[76:79], v[156:159]
    s_waitcnt vmcnt(6)
    s_barrier
    ds_read_b64_tr_b16 v[96:97], v16 offset:49152
    ds_read_b64_tr_b16 v[98:99], v16 offset:49664
    ds_read_b64_tr_b16 v[100:101], v17 offset:49152
    ds_read_b64_tr_b16 v[102:103], v17 offset:49664
    ds_read_b64_tr_b16 v[104:105], v18 offset:49152
    ds_read_b64_tr_b16 v[106:107], v18 offset:49664
    ds_read_b64_tr_b16 v[108:109], v19 offset:49152
    ds_read_b64_tr_b16 v[110:111], v19 offset:49664
    s_add_u32 m0, s58, 16384
    s_nop 0
    buffer_load_dwordx4 v3, s[40:43], s45 offen lds
    s_waitcnt lgkmcnt(6)
    v_mfma_f32_16x16x32_bf16 v[128:131], v[96:99], v[80:83], v[128:131]
    ds_read_b64_tr_b16 v[112:113], v16 offset:53248
    v_mfma_f32_16x16x32_bf16 v[132:135], v[96:99], v[84:87], v[132:135]
    ds_read_b64_tr_b16 v[114:115], v16 offset:53760
    buffer_load_dwordx4 v[48:51], v5, s[32:35], s44 offen offset:0
    s_waitcnt lgkmcnt(6)
    v_mfma_f32_16x16x32_bf16 v[136:139], v[100:103], v[80:83], v[136:139]
    ds_read_b64_tr_b16 v[116:117], v17 offset:53248
    v_mfma_f32_16x16x32_bf16 v[140:143], v[100:103], v[84:87], v[140:143]
    ds_read_b64_tr_b16 v[118:119], v17 offset:53760
    buffer_load_dwordx4 v[52:55], v5, s[32:35], s44 offen offset:1024
    s_waitcnt lgkmcnt(6)
    v_mfma_f32_16x16x32_bf16 v[144:147], v[104:107], v[80:83], v[144:147]
    ds_read_b64_tr_b16 v[120:121], v18 offset:53248
    v_mfma_f32_16x16x32_bf16 v[148:151], v[104:107], v[84:87], v[148:151]
    ds_read_b64_tr_b16 v[122:123], v18 offset:53760
    s_add_u32 m0, s58, 17408
    s_nop 0
    buffer_load_dwordx4 v4, s[40:43], s45 offen lds
    s_add_u32 s45, s45, 16384
    s_waitcnt lgkmcnt(6)
    v_mfma_f32_16x16x32_bf16 v[152:155], v[108:111], v[80:83], v[152:155]
    ds_read_b64_tr_b16 v[124:125], v19 offset:53248
    v_mfma_f32_16x16x32_bf16 v[156:159], v[108:111], v[84:87], v[156:159]
    ds_read_b64_tr_b16 v[126:127], v19 offset:53760
    buffer_load_dwordx4 v[56:59], v5, s[32:35], s44 offen offset:2048
    s_waitcnt lgkmcnt(6)
    v_mfma_f32_16x16x32_bf16 v[128:131], v[112:115], v[88:91], v[128:131]
    v_mfma_f32_16x16x32_bf16 v[132:135], v[112:115], v[92:95], v[132:135]
    buffer_load_dwordx4 v[60:63], v5, s[32:35], s44 offen offset:3072
    s_add_u32 s44, s44, 8192
    s_waitcnt lgkmcnt(4)
    v_mfma_f32_16x16x32_bf16 v[136:139], v[116:119], v[88:91], v[136:139]
    v_mfma_f32_16x16x32_bf16 v[140:143], v[116:119], v[92:95], v[140:143]
    s_waitcnt lgkmcnt(2)
    v_mfma_f32_16x16x32_bf16 v[144:147], v[120:123], v[88:91], v[144:147]
    v_mfma_f32_16x16x32_bf16 v[148:151], v[120:123], v[92:95], v[148:151]
    s_waitcnt lgkmcnt(0)
    v_mfma_f32_16x16x32_bf16 v[152:155], v[124:127], v[88:91], v[152:155]
    v_mfma_f32_16x16x32_bf16 v[156:159], v[124:127], v[92:95], v[156:159]
    s_sub_u32 s46, s46, 1
    s_cmp_lg_u32 s46, 0
    s_cbranch_scc1 K4_LOOP
    s_waitcnt vmcnt(0) lgkmcnt(0)
    s_barrier
    v_and_b32 v10, 15, v2
    v_lshrrev_b32 v11, 4, v2
    v_xor_b32 v11, v11, v10
    v_lshlrev_b32 v11, 4, v11
    v_lshl_add_u32 v11, v10, 8, v11
    s_lshl_b32 s57, s56, 15
    s_lshl_b32 s59, s55, 13
    s_add_u32 s57, s57, s59
    v_add_u32 v11, s57, v11
    v_xor_b32 v12, 0, v11
    ds_write_b128 v12, v[128:131] offset:0
    ds_write_b128 v12, v[132:135] offset:4096
    v_xor_b32 v12, 64, v11
    ds_write_b128 v12, v[136:139] offset:0
    ds_write_b128 v12, v[140:143] offset:4096
    v_xor_b32 v12, 128, v11
    ds_write_b128 v12, v[144:147] offset:0
    ds_write_b128 v12, v[148:151] offset:4096
    v_xor_b32 v12, 192, v11
    ds_write_b128 v12, v[152:155] offset:0
    ds_write_b128 v12, v[156:159] offset:4096
    v_lshrrev_b32 v13, 3, v0
    v_and_b32 v14, 7, v0
    s_lshl_b32 s57, s52, 7
    v_add_u32 v15, s57, v13
    v_lshlrev_b32 v15, 11, v15
    v_lshl_add_u32 v15, v14, 4, v15
    s_lshl_b32 s57, s53, 7
    v_add_u32 v15, s57, v15
    s_mov_b32 s59, 131072
    buffer_load_dwordx4 v[16:19], v15, s[20:23], 0 offen
    buffer_load_dwordx4 v[20:23], v15, s[20:23], s59 offen
    v_lshlrev_b32 v24, 5, v14
    s_lshl_b32 s57, s57, 1
    s_add_u32 s57, s57, 20480
    buffer_load_dwordx4 v[32:35], v24, s[24:27], s57 offen
    buffer_load_dwordx4 v[36:39], v24, s[24:27], s57 offen offset:16
    s_waitcnt lgkmcnt(0)
    s_barrier
    v_and_b32 v24, 15, v13
    v_lshlrev_b32 v25, 1, v14
    v_xor_b32 v25, v25, v24
    v_lshlrev_b32 v25, 4, v25
    v_lshl_add_u32 v25, v13, 8, v25
    v_xor_b32 v26, 16, v25
    s_waitcnt vmcnt(0)
    v_cvt_pk_bf16_f32 v28, v32, v33
    v_lshlrev_b32 v32, 16, v28
    v_and_b32 v33, s63, v28
    v_cvt_pk_bf16_f32 v28, v34, v35
    v_lshlrev_b32 v34, 16, v28
    v_and_b32 v35, s63, v28
    v_cvt_pk_bf16_f32 v28, v36, v37
    v_lshlrev_b32 v36, 16, v28
    v_and_b32 v37, s63, v28
    v_cvt_pk_bf16_f32 v28, v38, v39
    v_lshlrev_b32 v38, 16, v28
    v_and_b32 v39, s63, v28
    ds_read_b128 v[40:43], v25 offset:0
    ds_read_b128 v[44:47], v26 offset:0
    ds_read_b128 v[48:51], v25 offset:32768
    ds_read_b128 v[52:55], v26 offset:32768
    s_waitcnt lgkmcnt(0)
    v_add_f32 v40, v40, v48
    v_add_f32 v41, v41, v49
    v_add_f32 v42, v42, v50
    v_add_f32 v43, v43, v51
    v_add_f32 v44, v44, v52
    v_add_f32 v45, v45, v53
    v_add_f32 v46, v46, v54
    v_add_f32 v47, v47, v55
    v_cvt_pk_bf16_f32 v56, v40, v41
    v_lshlrev_b32 v40, 16, v56
    v_and_b32 v41, s63, v56
    v_cvt_pk_bf16_f32 v56, v42, v43
    v_lshlrev_b32 v42, 16, v56
    v_and_b32 v43, s63, v56
    v_cvt_pk_bf16_f32 v56, v44, v45
    v_lshlrev_b32 v44, 16, v56
    v_and_b32 v45, s63, v56
    v_cvt_pk_bf16_f32 v56, v46, v47
    v_lshlrev_b32 v46, 16, v56
    v_and_b32 v47, s63, v56
    v_mul_f32 v40, v40, v32
    v_mul_f32 v41, v41, v33
    v_mul_f32 v42, v42, v34
    v_mul_f32 v43, v43, v35
    v_mul_f32 v44, v44, v36
    v_mul_f32 v45, v45, v37
    v_mul_f32 v46, v46, v38
    v_mul_f32 v47, v47, v39
    v_lshlrev_b32 v48, 16, v16
    v_and_b32 v49, s63, v16
    v_lshlrev_b32 v50, 16, v17
    v_and_b32 v51, s63, v17
    v_lshlrev_b32 v52, 16, v18
    v_and_b32 v53, s63, v18
    v_lshlrev_b32 v54, 16, v19
    v_and_b32 v55, s63, v19
    v_add_f32 v40, v40, v48
    v_add_f32 v41, v41, v49
    v_add_f32 v42, v42, v50
    v_add_f32 v43, v43, v51
    v_add_f32 v44, v44, v52
    v_add_f32 v45, v45, v53
    v_add_f32 v46, v46, v54
    v_add_f32 v47, v47, v55
    v_cvt_pk_bf16_f32 v58, v40, v41
    v_cvt_pk_bf16_f32 v59, v42, v43
    v_cvt_pk_bf16_f32 v60, v44, v45
    v_cvt_pk_bf16_f32 v61, v46, v47
    buffer_store_dwordx4 v[58:61], v15, s[12:15], 0 offen
    ds_read_b128 v[40:43], v25 offset:16384
    ds_read_b128 v[44:47], v26 offset:16384
    ds_read_b128 v[48:51], v25 offset:49152
    ds_read_b128 v[52:55], v26 offset:49152
    s_waitcnt lgkmcnt(0)
    v_add_f32 v40, v40, v48
    v_add_f32 v41, v41, v49
    v_add_f32 v42, v42, v50
    v_add_f32 v43, v43, v51
    v_add_f32 v44, v44, v52
    v_add_f32 v45, v45, v53
    v_add_f32 v46, v46, v54
    v_add_f32 v47, v47, v55
    v_cvt_pk_bf16_f32 v56, v40, v41
    v_lshlrev_b32 v40, 16, v56
    v_and_b32 v41, s63, v56
    v_cvt_pk_bf16_f32 v56, v42, v43
    v_lshlrev_b32 v42, 16, v56
    v_and_b32 v43, s63, v56
    v_cvt_pk_bf16_f32 v56, v44, v45
    v_lshlrev_b32 v44, 16, v56
    v_and_b32 v45, s63, v56
    v_cvt_pk_bf16_f32 v56, v46, v47
    v_lshlrev_b32 v46, 16, v56
    v_and_b32 v47, s63, v56
    v_mul_f32 v40, v40, v32
    v_mul_f32 v41, v41, v33
    v_mul_f32 v42, v42, v34
    v_mul_f32 v43, v43, v35
    v_mul_f32 v44, v44, v36
    v_mul_f32 v45, v45, v37
    v_mul_f32 v46, v46, v38
    v_mul_f32 v47, v47, v39
    v_lshlrev_b32 v48, 16, v20
    v_and_b32 v49, s63, v20
    v_lshlrev_b32 v50, 16, v21
    v_and_b32 v51, s63, v21
    v_lshlrev_b32 v52, 16, v22
    v_and_b32 v53, s63, v22
    v_lshlrev_b32 v54, 16, v23
    v_and_b32 v55, s63, v23
    v_add_f32 v40, v40, v48
    v_add_f32 v41, v41, v49
    v_add_f32 v42, v42, v50
    v_add_f32 v43, v43, v51
    v_add_f32 v44, v44, v52
    v_add_f32 v45, v45, v53
    v_add_f32 v46, v46, v54
    v_add_f32 v47, v47, v55
    v_cvt_pk_bf16_f32 v62, v40, v41
    v_cvt_pk_bf16_f32 v63, v42, v43
    v_cvt_pk_bf16_f32 v64, v44, v45
    v_cvt_pk_bf16_f32 v65, v46, v47
    buffer_store_dwordx4 v[62:65], v15, s[12:15], s59 offen
K4_END:
    s_endpgm
TEXT_END:
    s_endpgm
.section .rodata,"a"
.p2align 6
.amdhsa_kernel front_kernel
  .amdhsa_next_free_vgpr 256
  .amdhsa_next_free_sgpr 102
  .amdhsa_accum_offset 256
  .amdhsa_group_segment_fixed_size 0
  .amdhsa_kernarg_size 120
  .amdhsa_user_sgpr_count 2
  .amdhsa_user_sgpr_kernarg_segment_ptr 1
  .amdhsa_system_sgpr_workgroup_id_x 1
  .amdhsa_float_denorm_mode_32 3
.end_amdhsa_kernel
.amdhsa_kernel ffn2_kernel
  .amdhsa_next_free_vgpr 160
  .amdhsa_next_free_sgpr 102
  .amdhsa_accum_offset 160
  .amdhsa_group_segment_fixed_size 0
  .amdhsa_kernarg_size 120
  .amdhsa_user_sgpr_count 2
  .amdhsa_user_sgpr_kernarg_segment_ptr 1
  .amdhsa_system_sgpr_workgroup_id_x 1
  .amdhsa_float_denorm_mode_32 3
.end_amdhsa_kernel
```
